```python
import torch

def _softmax(x, axis=-1):
    return torch.softmax(x, dim=axis)
def _gelu(x):
    return torch.nn.functional.gelu(x, approximate="tanh")
def _silu(x):
    return torch.nn.functional.silu(x)
def _sigmoid(x):
    return torch.sigmoid(x)
def _layernorm(x, axis=-1, eps=1e-5):
    m = x.mean(dim=axis, keepdim=True)
    v = x.var(dim=axis, keepdim=True, unbiased=False)
    return (x - m) / torch.sqrt(v + eps)
def _scatter_add(tgt, idx, src, axis=0):
    return tgt.clone().index_add_(axis, idx, src)
def _segment_sum(src, seg, n):
    out = torch.zeros((n,) + src.shape[1:], dtype=src.dtype)
    return out.index_add_(0, seg, src)
def _pad(x, pw):
    flat = tuple(v for pair in reversed(pw) for v in pair)
    return torch.nn.functional.pad(x, flat)

kernel_name = 'recurrent_scan__sliding_block_cached__mixer_token_mlp__decode'

def setup_inputs():

    _w = (lambda a: (lambda t: t.to(torch.bfloat16) if t.is_floating_point() else t)(torch.as_tensor(a)))
    def _A_setup():
        B, Sq, D = 1, 1, 640
        Hq, Hkv, Sk, Dh = 32, 32, 32768, 192
        assert Hq % Hkv == 0, (Hq, Hkv)
        return {
            "x": _w((lambda *s: torch.randn(*s, dtype=torch.bfloat16) * 0.1)(B, Sq, D)),
            "k_cache": _w((lambda *s: torch.randn(*s, dtype=torch.bfloat16) * 0.8)(B, Hkv, Sk, Dh)),
            "v_cache": _w((lambda *s: torch.randn(*s, dtype=torch.bfloat16) * 3.2)(B, Hkv, Sk, Dh)),
            "wq": _w((lambda *s: torch.randn(*s, dtype=torch.bfloat16) * 0.8)(D, Hq * Dh) * (D ** -0.5)),
            "wo": _w((lambda *s: torch.randn(*s, dtype=torch.bfloat16) * 3.2)(Hq * Dh, D) * ((Hq * Dh) ** -0.5)),
        }
    _A_in = _A_setup()

    def _B_setup():
        B, S, D, F = 1, 1, 640, 1536
        return {
            "x": _w((lambda *s: torch.randn(*s, dtype=torch.bfloat16) * 0.1)(B, S, D)),
            "w1": _w((lambda *s: torch.randn(*s, dtype=torch.bfloat16) * 3.2)(S, F) * (S ** -0.5)),
            "b1": _w((lambda *s: torch.randn(*s, dtype=torch.bfloat16) * 3.2)(F) * 0.02),
            "w2": _w((lambda *s: torch.randn(*s, dtype=torch.bfloat16) * 3.2)(F, S) * (F ** -0.5)),
            "b2": _w((lambda *s: torch.randn(*s, dtype=torch.bfloat16) * 3.2)(S) * 0.02),
        }
    _B_in = _B_setup()

    return {
        "A_x": _A_in["x"],
        "A_k_cache": _A_in["k_cache"],
        "A_v_cache": _A_in["v_cache"],
        "A_wq": _A_in["wq"],
        "A_wo": _A_in["wo"],
        "B_x": _B_in["x"],
        "B_w1": _B_in["w1"],
        "B_b1": _B_in["b1"],
        "B_w2": _B_in["w2"],
        "B_b2": _B_in["b2"],
    }

def reference(A_x, A_k_cache, A_v_cache, A_wq, A_wo, B_x, B_w1, B_b1, B_w2, B_b2):
    def _A_ref(x, k_cache, v_cache, wq, wo):
        B, Sq, D = x.shape
        Hq, Dh = 32, 192
        Hkv, Sk = k_cache.shape[1], k_cache.shape[2]
        W = min(4096, max(256, Sk // 4))
        rep = Hq // Hkv
        q = (lambda x, *d: x.permute(*d))((x @ wq).reshape(B, Sq, Hq, Dh), 0, 2, 1, 3)
        k = (lambda x, n, axis: torch.repeat_interleave(x, n, dim=axis))(k_cache[:, :, Sk - W:, :], rep, axis=1)
        v = (lambda x, n, axis: torch.repeat_interleave(x, n, dim=axis))(v_cache[:, :, Sk - W:, :], rep, axis=1)
        scores = torch.einsum("bhqd,bhkd->bhqk", q, k) * (Dh ** -0.5)
        p = _softmax(scores, axis=-1)
        o = torch.einsum("bhqk,bhkd->bhqd", p, v)
        return (lambda x, *d: x.permute(*d))(o, 0, 2, 1, 3).reshape(B, Sq, Hq * Dh) @ wo

    def _B_ref(x, w1, b1, w2, b2):
        B, S, D = x.shape
        h = _layernorm(x, axis=-1)
        u = torch.einsum("bsd,sf->bdf", h, w1) + b1
        u = _gelu(u)
        y = torch.einsum("bdf,fs->bds", u, w2) + b2
        return (lambda x, *d: x.permute(*d))(y, 0, 2, 1)

    x = A_x
    xn = _layernorm(x, axis=-1)
    s = _A_ref(xn, A_k_cache, A_v_cache, A_wq, A_wo)
    g = _silu(_B_ref(xn, B_w1, B_b1, B_w2, B_b2))
    return x + s * g
```

```asm
; @launch grid=(256,1,1) block=(512,1,1) lds=159360
.amdgcn_target "amdgcn-amd-amdhsa--gfx950"
.text
.globl recurrent_scan__sliding_block_cached__mixer_token_mlp__decode_kernel
.p2align 8
.type recurrent_scan__sliding_block_cached__mixer_token_mlp__decode_kernel,@function
recurrent_scan__sliding_block_cached__mixer_token_mlp__decode_kernel:
s_cmp_ge_u32 s2, 256
s_cbranch_scc1 K_END
s_load_dwordx8 s[4:11], s[0:1], 0
s_load_dwordx2 s[74:75], s[0:1], 32
s_load_dwordx8 s[64:71], s[0:1], 48
s_load_dwordx4 s[76:79], s[0:1], 80
s_load_dwordx2 s[72:73], s[0:1], 96
s_memrealtime s[98:99]
v_and_b32 v1, 63, v0
v_lshrrev_b32 v2, 6, v0
s_nop 0
v_readfirstlane_b32 s24, v2
s_and_b32 s25, s2, 7
s_lshl_b32 s25, s25, 2
s_lshr_b32 s26, s2, 3
s_and_b32 s26, s26, 3
s_or_b32 s25, s25, s26
s_lshr_b32 s26, s2, 5
s_lshl_b32 s31, s25, 3
s_add_u32 s31, s31, s26
s_waitcnt lgkmcnt(0)
s_mov_b32 s44, s4
s_and_b32 s45, s5, 0xffff
s_mov_b32 s46, 0x500
s_mov_b32 s47, 0x00020000
s_mov_b32 s12, s6
s_and_b32 s13, s7, 0xffff
s_mov_b32 s14, 0x18000000
s_mov_b32 s15, 0x00020000
s_mov_b32 s16, s8
s_and_b32 s17, s9, 0xffff
s_mov_b32 s18, 0x18000000
s_mov_b32 s19, 0x00020000
s_mov_b32 s48, s10
s_and_b32 s49, s11, 0xffff
s_mov_b32 s50, 0x780000
s_mov_b32 s51, 0x00020000
s_mov_b32 s20, s72
s_and_b32 s21, s73, 0xffff
s_mov_b32 s22, 0x300000
s_mov_b32 s23, 0x00020000
s_mov_b32 s52, s74
s_and_b32 s53, s75, 0xffff
s_mov_b32 s54, 0x780000
s_mov_b32 s55, 0x00020000
s_mov_b32 s56, s78
s_and_b32 s57, s79, 0xffff
s_mov_b32 s58, 0x100
s_mov_b32 s59, 0x00020000
s_mov_b32 s99, s98
s_or_b32 s98, s98, 1
v_mov_b32 v250, s98
v_mov_b32 v251, 0
s_lshl_b32 s27, s25, 2
s_add_u32 s27, s27, 128
v_cmp_eq_u32 vcc, 0, v0
s_and_saveexec_b64 s[40:41], vcc
s_cbranch_execz NO_CAS
buffer_atomic_cmpswap v[250:251], off, s[56:59], s27 sc0
NO_CAS:
s_mov_b64 exec, s[40:41]
v_lshlrev_b32 v3, 2, v1
buffer_load_dword v20, v3, s[44:47], 0 offen offset:0
buffer_load_dword v21, v3, s[44:47], 0 offen offset:256
buffer_load_dword v22, v3, s[44:47], 0 offen offset:512
buffer_load_dword v23, v3, s[44:47], 0 offen offset:768
buffer_load_dword v24, v3, s[44:47], 0 offen offset:1024
v_lshrrev_b32 v9, 4, v1
v_and_b32 v4, 15, v1
v_mul_u32_u24 v16, 12288, v9
v_lshl_add_u32 v16, v4, 4, v16
s_lshr_b32 s27, s26, 1
s_mul_i32 s27, s27, 160
s_mul_i32 s30, s24, 20
s_add_u32 s27, s27, s30
s_mov_b32 s39, s27
s_mul_i32 s27, s27, 12288
s_mul_i32 s30, s25, 384
s_add_u32 s27, s27, s30
s_and_b32 s30, s26, 1
s_mul_i32 s30, s30, 192
s_add_u32 s27, s27, s30
v_cmp_gt_u32 vcc, 12, v4
s_and_saveexec_b64 s[40:41], vcc
buffer_load_dwordx4 v[32:35], v16, s[48:51], s27 offen nt
s_add_u32 s27, s27, 49152
buffer_load_dwordx4 v[36:39], v16, s[48:51], s27 offen nt
s_add_u32 s27, s27, 49152
buffer_load_dwordx4 v[40:43], v16, s[48:51], s27 offen nt
s_add_u32 s27, s27, 49152
buffer_load_dwordx4 v[44:47], v16, s[48:51], s27 offen nt
s_add_u32 s27, s27, 49152
buffer_load_dwordx4 v[48:51], v16, s[48:51], s27 offen nt
s_mov_b64 exec, s[40:41]
v_add_u32 v5, 0, v1
v_mul_u32_u24 v6, 2731, v5
v_lshrrev_b32 v4, 16, v6
v_lshlrev_b32 v13, 2, v4
v_add_u32 v5, 64, v1
v_mul_u32_u24 v6, 2731, v5
v_lshrrev_b32 v4, 16, v6
v_lshlrev_b32 v14, 2, v4
v_add_u32 v5, 128, v1
v_mul_u32_u24 v6, 2731, v5
v_lshrrev_b32 v4, 16, v6
v_lshlrev_b32 v15, 2, v4
s_mul_i32 s28, s25, 12582912
s_lshl_b32 s29, s26, 9
s_lshl_b32 s30, s24, 6
s_add_u32 s29, s29, s30
s_add_u32 s29, s29, 28672
s_mul_i32 s29, s29, 384
s_add_u32 s28, s28, s29
v_and_b32 v8, 15, v1
v_mul_u32_u24 v8, 384, v8
v_lshl_add_u32 v8, v9, 4, v8
v_mul_u32_u24 v5, 6912, v2
v_lshl_add_u32 v5, v1, 5, v5
v_lshlrev_b32 v6, 4, v1
v_lshrrev_b32 v4, 3, v0
v_and_b32 v7, 7, v0
v_add_u32 v17, 0, v4
v_subrev_u32 v3, 24, v17
v_cmp_le_u32 vcc, 24, v17
s_nop 1
v_cndmask_b32 v17, v17, v3, vcc
v_lshlrev_b32 v17, 5, v17
v_lshl_add_u32 v10, v7, 2, v17
v_add_u32 v17, 8, v4
v_subrev_u32 v3, 24, v17
v_cmp_le_u32 vcc, 24, v17
s_nop 1
v_cndmask_b32 v17, v17, v3, vcc
v_lshlrev_b32 v17, 5, v17
v_lshl_add_u32 v11, v7, 2, v17
v_add_u32 v17, 16, v4
v_subrev_u32 v3, 24, v17
v_cmp_le_u32 vcc, 24, v17
s_nop 1
v_cndmask_b32 v17, v17, v3, vcc
v_lshlrev_b32 v17, 5, v17
v_lshl_add_u32 v12, v7, 2, v17
s_waitcnt vmcnt(5)
v_readfirstlane_b32 s38, v250
v_and_b32 v31, 0xffff0000, v24
v_lshlrev_b32 v30, 16, v24
v_and_b32 v29, 0xffff0000, v23
v_lshlrev_b32 v28, 16, v23
v_and_b32 v27, 0xffff0000, v22
v_lshlrev_b32 v26, 16, v22
v_and_b32 v25, 0xffff0000, v21
v_lshlrev_b32 v24, 16, v21
v_and_b32 v23, 0xffff0000, v20
v_lshlrev_b32 v22, 16, v20
s_cmp_eq_u32 s38, 0
s_cselect_b32 s38, s98, s38
s_cmp_eq_u32 s24, 0
s_cbranch_scc0 NO_NW
v_mov_b32 v250, s38
v_mov_b32 v251, 0
ds_write_b32 v251, v250 offset:55872
NO_NW:
v_mov_b32 v248, v22
v_add_f32 v248, v248, v23
v_add_f32 v248, v248, v24
v_add_f32 v248, v248, v25
v_add_f32 v248, v248, v26
v_add_f32 v248, v248, v27
v_add_f32 v248, v248, v28
v_add_f32 v248, v248, v29
v_add_f32 v248, v248, v30
v_add_f32 v248, v248, v31
s_nop 1
v_add_f32_dpp v248, v248, v248 quad_perm:[1,0,3,2] row_mask:0xf bank_mask:0xf
s_nop 1
v_add_f32_dpp v248, v248, v248 quad_perm:[2,3,0,1] row_mask:0xf bank_mask:0xf
s_nop 1
v_add_f32_dpp v248, v248, v248 row_half_mirror row_mask:0xf bank_mask:0xf
s_nop 1
v_add_f32_dpp v248, v248, v248 row_mirror row_mask:0xf bank_mask:0xf
s_nop 1
v_add_f32_dpp v248, v248, v248 row_bcast:15 row_mask:0xa bank_mask:0xf
s_nop 1
v_add_f32_dpp v248, v248, v248 row_bcast:31 row_mask:0xc bank_mask:0xf
s_nop 1
v_readlane_b32 s36, v248, 63
s_nop 3
v_mov_b32 v248, s36
v_mul_f32 v248, 0x3acccccd, v248
v_mov_b32 v249, 0
v_sub_f32 v250, v22, v248
v_fmac_f32 v249, v250, v250
v_sub_f32 v250, v23, v248
v_fmac_f32 v249, v250, v250
v_sub_f32 v250, v24, v248
v_fmac_f32 v249, v250, v250
v_sub_f32 v250, v25, v248
v_fmac_f32 v249, v250, v250
v_sub_f32 v250, v26, v248
v_fmac_f32 v249, v250, v250
v_sub_f32 v250, v27, v248
v_fmac_f32 v249, v250, v250
v_sub_f32 v250, v28, v248
v_fmac_f32 v249, v250, v250
v_sub_f32 v250, v29, v248
v_fmac_f32 v249, v250, v250
v_sub_f32 v250, v30, v248
v_fmac_f32 v249, v250, v250
v_sub_f32 v250, v31, v248
v_fmac_f32 v249, v250, v250
s_nop 1
v_add_f32_dpp v249, v249, v249 quad_perm:[1,0,3,2] row_mask:0xf bank_mask:0xf
s_nop 1
v_add_f32_dpp v249, v249, v249 quad_perm:[2,3,0,1] row_mask:0xf bank_mask:0xf
s_nop 1
v_add_f32_dpp v249, v249, v249 row_half_mirror row_mask:0xf bank_mask:0xf
s_nop 1
v_add_f32_dpp v249, v249, v249 row_mirror row_mask:0xf bank_mask:0xf
s_nop 1
v_add_f32_dpp v249, v249, v249 row_bcast:15 row_mask:0xa bank_mask:0xf
s_nop 1
v_add_f32_dpp v249, v249, v249 row_bcast:31 row_mask:0xc bank_mask:0xf
s_nop 1
v_readlane_b32 s37, v249, 63
s_nop 3
v_mov_b32 v249, s37
v_mul_f32 v249, 0x3acccccd, v249
v_cvt_pk_bf16_f32 v250, v249, v249
v_lshlrev_b32 v249, 16, v250
v_add_f32 v249, 0x3727c5ac, v249
v_cvt_pk_bf16_f32 v250, v249, v249
v_lshlrev_b32 v249, 16, v250
v_sqrt_f32 v249, v249
s_nop 0
v_cvt_pk_bf16_f32 v250, v249, v249
v_lshlrev_b32 v249, 16, v250
v_rcp_f32 v249, v249
s_nop 0
v_cvt_pk_bf16_f32 v250, v248, v248
v_lshlrev_b32 v248, 16, v250
v_sub_f32 v22, v22, v248
v_cvt_pk_bf16_f32 v250, v22, v22
v_lshlrev_b32 v22, 16, v250
v_mul_f32 v22, v22, v249
v_cvt_pk_bf16_f32 v250, v22, v22
v_lshlrev_b32 v22, 16, v250
v_sub_f32 v23, v23, v248
v_cvt_pk_bf16_f32 v250, v23, v23
v_lshlrev_b32 v23, 16, v250
v_mul_f32 v23, v23, v249
v_cvt_pk_bf16_f32 v250, v23, v23
v_lshlrev_b32 v23, 16, v250
v_sub_f32 v24, v24, v248
v_cvt_pk_bf16_f32 v250, v24, v24
v_lshlrev_b32 v24, 16, v250
v_mul_f32 v24, v24, v249
v_cvt_pk_bf16_f32 v250, v24, v24
v_lshlrev_b32 v24, 16, v250
v_sub_f32 v25, v25, v248
v_cvt_pk_bf16_f32 v250, v25, v25
v_lshlrev_b32 v25, 16, v250
v_mul_f32 v25, v25, v249
v_cvt_pk_bf16_f32 v250, v25, v25
v_lshlrev_b32 v25, 16, v250
v_sub_f32 v26, v26, v248
v_cvt_pk_bf16_f32 v250, v26, v26
v_lshlrev_b32 v26, 16, v250
v_mul_f32 v26, v26, v249
v_cvt_pk_bf16_f32 v250, v26, v26
v_lshlrev_b32 v26, 16, v250
v_sub_f32 v27, v27, v248
v_cvt_pk_bf16_f32 v250, v27, v27
v_lshlrev_b32 v27, 16, v250
v_mul_f32 v27, v27, v249
v_cvt_pk_bf16_f32 v250, v27, v27
v_lshlrev_b32 v27, 16, v250
v_sub_f32 v28, v28, v248
v_cvt_pk_bf16_f32 v250, v28, v28
v_lshlrev_b32 v28, 16, v250
v_mul_f32 v28, v28, v249
v_cvt_pk_bf16_f32 v250, v28, v28
v_lshlrev_b32 v28, 16, v250
v_sub_f32 v29, v29, v248
v_cvt_pk_bf16_f32 v250, v29, v29
v_lshlrev_b32 v29, 16, v250
v_mul_f32 v29, v29, v249
v_cvt_pk_bf16_f32 v250, v29, v29
v_lshlrev_b32 v29, 16, v250
v_sub_f32 v30, v30, v248
v_cvt_pk_bf16_f32 v250, v30, v30
v_lshlrev_b32 v30, 16, v250
v_mul_f32 v30, v30, v249
v_cvt_pk_bf16_f32 v250, v30, v30
v_lshlrev_b32 v30, 16, v250
v_sub_f32 v31, v31, v248
v_cvt_pk_bf16_f32 v250, v31, v31
v_lshlrev_b32 v31, 16, v250
v_mul_f32 v31, v31, v249
v_cvt_pk_bf16_f32 v250, v31, v31
v_lshlrev_b32 v31, 16, v250
v_mul_u32_u24 v17, 2560, v2
v_add_u32 v17, 59008, v17
v_lshl_add_u32 v7, v1, 3, v17
ds_write_b64 v7, v[22:23] offset:0
ds_write_b64 v7, v[24:25] offset:512
ds_write_b64 v7, v[26:27] offset:1024
ds_write_b64 v7, v[28:29] offset:1536
ds_write_b64 v7, v[30:31] offset:2048
s_lshl_b32 s39, s39, 2
v_lshl_add_u32 v17, v9, 2, v17
v_add_u32 v17, s39, v17
s_waitcnt lgkmcnt(0)
ds_read_b32 v20, v17 offset:0
ds_read_b32 v21, v17 offset:16
ds_read_b32 v22, v17 offset:32
ds_read_b32 v23, v17 offset:48
ds_read_b32 v24, v17 offset:64
v_mov_b32 v248, 0
v_mov_b32 v249, 0
v_mov_b32 v250, 0
v_mov_b32 v251, 0
v_mov_b32 v252, 0
v_mov_b32 v253, 0
v_mov_b32 v254, 0
v_mov_b32 v255, 0
s_waitcnt vmcnt(0) lgkmcnt(0)
v_lshlrev_b32 v30, 16, v32
v_and_b32 v31, 0xffff0000, v32
v_fmac_f32 v248, v30, v20
v_fmac_f32 v249, v31, v20
v_lshlrev_b32 v30, 16, v33
v_and_b32 v31, 0xffff0000, v33
v_fmac_f32 v250, v30, v20
v_fmac_f32 v251, v31, v20
v_lshlrev_b32 v30, 16, v34
v_and_b32 v31, 0xffff0000, v34
v_fmac_f32 v252, v30, v20
v_fmac_f32 v253, v31, v20
v_lshlrev_b32 v30, 16, v35
v_and_b32 v31, 0xffff0000, v35
v_fmac_f32 v254, v30, v20
v_fmac_f32 v255, v31, v20
v_lshlrev_b32 v30, 16, v36
v_and_b32 v31, 0xffff0000, v36
v_fmac_f32 v248, v30, v21
v_fmac_f32 v249, v31, v21
v_lshlrev_b32 v30, 16, v37
v_and_b32 v31, 0xffff0000, v37
v_fmac_f32 v250, v30, v21
v_fmac_f32 v251, v31, v21
v_lshlrev_b32 v30, 16, v38
v_and_b32 v31, 0xffff0000, v38
v_fmac_f32 v252, v30, v21
v_fmac_f32 v253, v31, v21
v_lshlrev_b32 v30, 16, v39
v_and_b32 v31, 0xffff0000, v39
v_fmac_f32 v254, v30, v21
v_fmac_f32 v255, v31, v21
v_lshlrev_b32 v30, 16, v40
v_and_b32 v31, 0xffff0000, v40
v_fmac_f32 v248, v30, v22
v_fmac_f32 v249, v31, v22
v_lshlrev_b32 v30, 16, v41
v_and_b32 v31, 0xffff0000, v41
v_fmac_f32 v250, v30, v22
v_fmac_f32 v251, v31, v22
v_lshlrev_b32 v30, 16, v42
v_and_b32 v31, 0xffff0000, v42
v_fmac_f32 v252, v30, v22
v_fmac_f32 v253, v31, v22
v_lshlrev_b32 v30, 16, v43
v_and_b32 v31, 0xffff0000, v43
v_fmac_f32 v254, v30, v22
v_fmac_f32 v255, v31, v22
v_lshlrev_b32 v30, 16, v44
v_and_b32 v31, 0xffff0000, v44
v_fmac_f32 v248, v30, v23
v_fmac_f32 v249, v31, v23
v_lshlrev_b32 v30, 16, v45
v_and_b32 v31, 0xffff0000, v45
v_fmac_f32 v250, v30, v23
v_fmac_f32 v251, v31, v23
v_lshlrev_b32 v30, 16, v46
v_and_b32 v31, 0xffff0000, v46
v_fmac_f32 v252, v30, v23
v_fmac_f32 v253, v31, v23
v_lshlrev_b32 v30, 16, v47
v_and_b32 v31, 0xffff0000, v47
v_fmac_f32 v254, v30, v23
v_fmac_f32 v255, v31, v23
v_lshlrev_b32 v30, 16, v48
v_and_b32 v31, 0xffff0000, v48
v_fmac_f32 v248, v30, v24
v_fmac_f32 v249, v31, v24
v_lshlrev_b32 v30, 16, v49
v_and_b32 v31, 0xffff0000, v49
v_fmac_f32 v250, v30, v24
v_fmac_f32 v251, v31, v24
v_lshlrev_b32 v30, 16, v50
v_and_b32 v31, 0xffff0000, v50
v_fmac_f32 v252, v30, v24
v_fmac_f32 v253, v31, v24
v_lshlrev_b32 v30, 16, v51
v_and_b32 v31, 0xffff0000, v51
v_fmac_f32 v254, v30, v24
v_fmac_f32 v255, v31, v24
v_lshlrev_b32 v3, 5, v0
ds_write_b128 v3, v[248:251] offset:32768
ds_write_b128 v3, v[252:255] offset:32784
s_waitcnt lgkmcnt(0)
s_barrier
v_mov_b32 v251, 0
ds_read_b32 v250, v251 offset:55872
s_waitcnt lgkmcnt(0)
v_readfirstlane_b32 s38, v250
s_nop 3
s_mov_b32 s29, s28
s_mov_b32 s30, s28
s_cmp_ge_u32 s24, 3
s_cbranch_scc1 Q_OTHER
s_cmp_ge_u32 s24, 2
s_cbranch_scc1 Q_POLL
v_lshrrev_b32 v3, 3, v0
v_and_b32 v4, 7, v0
v_lshlrev_b32 v3, 5, v3
v_lshl_add_u32 v3, v4, 2, v3
ds_read_b32 v32, v3 offset:32768
ds_read_b32 v33, v3 offset:33280
ds_read_b32 v34, v3 offset:33792
ds_read_b32 v35, v3 offset:34304
ds_read_b32 v36, v3 offset:34816
ds_read_b32 v37, v3 offset:35328
ds_read_b32 v38, v3 offset:35840
ds_read_b32 v39, v3 offset:36352
ds_read_b32 v40, v3 offset:36864
ds_read_b32 v41, v3 offset:37376
ds_read_b32 v42, v3 offset:37888
ds_read_b32 v43, v3 offset:38400
ds_read_b32 v44, v3 offset:38912
ds_read_b32 v45, v3 offset:39424
ds_read_b32 v46, v3 offset:39936
ds_read_b32 v47, v3 offset:40448
ds_read_b32 v48, v3 offset:40960
ds_read_b32 v49, v3 offset:41472
ds_read_b32 v50, v3 offset:41984
ds_read_b32 v51, v3 offset:42496
ds_read_b32 v52, v3 offset:43008
ds_read_b32 v53, v3 offset:43520
ds_read_b32 v54, v3 offset:44032
ds_read_b32 v55, v3 offset:44544
ds_read_b32 v56, v3 offset:45056
ds_read_b32 v57, v3 offset:45568
ds_read_b32 v58, v3 offset:46080
ds_read_b32 v59, v3 offset:46592
ds_read_b32 v60, v3 offset:47104
ds_read_b32 v61, v3 offset:47616
ds_read_b32 v62, v3 offset:48128
ds_read_b32 v63, v3 offset:48640
s_waitcnt lgkmcnt(0)
v_add_f32 v32, v32, v33
v_add_f32 v32, v32, v34
v_add_f32 v32, v32, v35
v_add_f32 v32, v32, v36
v_add_f32 v32, v32, v37
v_add_f32 v32, v32, v38
v_add_f32 v32, v32, v39
v_add_f32 v32, v32, v40
v_add_f32 v32, v32, v41
v_add_f32 v32, v32, v42
v_add_f32 v32, v32, v43
v_add_f32 v32, v32, v44
v_add_f32 v32, v32, v45
v_add_f32 v32, v32, v46
v_add_f32 v32, v32, v47
v_add_f32 v32, v32, v48
v_add_f32 v32, v32, v49
v_add_f32 v32, v32, v50
v_add_f32 v32, v32, v51
v_add_f32 v32, v32, v52
v_add_f32 v32, v32, v53
v_add_f32 v32, v32, v54
v_add_f32 v32, v32, v55
v_add_f32 v32, v32, v56
v_add_f32 v32, v32, v57
v_add_f32 v32, v32, v58
v_add_f32 v32, v32, v59
v_add_f32 v32, v32, v60
v_add_f32 v32, v32, v61
v_add_f32 v32, v32, v62
v_add_f32 v32, v32, v63
v_mov_b32 v33, s38
s_lshl_b32 s27, s31, 10
s_add_u32 s27, s27, 0
v_lshlrev_b32 v3, 3, v0
v_cmp_gt_u32 vcc, 96, v0
s_and_saveexec_b64 s[40:41], vcc
buffer_store_dwordx2 v[32:33], v3, s[20:23], s27 offen sc1
s_mov_b64 exec, s[40:41]
Q_POLL:
s_lshl_b32 s27, s25, 13
s_add_u32 s27, s27, 0
v_cmp_le_u32 vcc, 96, v0
v_lshlrev_b32 v3, 3, v0
v_add_u32 v4, 256, v3
s_nop 1
v_cndmask_b32 v3, v3, v4, vcc
s_add_u32 s33, s27, 4096
s_mov_b32 s60, 0
PQ:
buffer_load_dwordx2 v[32:33], v3, s[20:23], s27 offen offset:0 sc1
buffer_load_dwordx2 v[34:35], v3, s[20:23], s27 offen offset:2048 sc1
buffer_load_dwordx2 v[36:37], v3, s[20:23], s33 offen offset:0 sc1
buffer_load_dwordx2 v[38:39], v3, s[20:23], s33 offen offset:2048 sc1
s_waitcnt vmcnt(0)
v_cmp_ne_u32 vcc, s38, v33
v_cmp_ne_u32 s[42:43], s38, v35
s_or_b64 vcc, vcc, s[42:43]
v_cmp_ne_u32 s[42:43], s38, v37
s_or_b64 vcc, vcc, s[42:43]
v_cmp_ne_u32 s[42:43], s38, v39
s_or_b64 vcc, vcc, s[42:43]
s_cbranch_vccz PQ_D
s_sleep 1
s_add_u32 s60, s60, 1
s_cmp_lt_u32 s60, 65536
s_cbranch_scc1 PQ
PQ_D:
v_add_f32 v32, v32, v34
v_add_f32 v36, v36, v38
v_add_f32 v32, v32, v36
v_cvt_pk_bf16_f32 v32, v32, v32
v_lshlrev_b32 v4, 1, v0
ds_write_b16 v4, v32 offset:55296
s_mov_b32 s37, 0
s_branch Q_DONE
Q_OTHER:
s_mov_b32 s37, 1
Q_DONE:
s_waitcnt lgkmcnt(0)
s_barrier
v_lshrrev_b32 v3, 3, v0
v_mul_u32_u24 v3, 2304, v3
v_and_b32 v4, 7, v0
v_lshl_add_u32 v3, v4, 5, v3
v_mov_b32 v28, 0
v_mov_b32 v29, 0
v_mov_b32 v30, 0
v_mov_b32 v31, 0
v_cmp_gt_u32 vcc, 192, v0
s_and_saveexec_b64 s[40:41], vcc
ds_write_b128 v3, v[28:31] offset:2048
ds_write_b128 v3, v[28:31] offset:2064
s_mov_b64 exec, s[40:41]
v_add_u32 v4, 0, v1
v_mul_u32_u24 v3, 6, v13
v_sub_u32 v4, v4, v3
v_lshlrev_b32 v4, 4, v4
ds_read_b128 v[128:131], v4 offset:55296
v_add_u32 v4, 64, v1
v_mul_u32_u24 v3, 6, v14
v_sub_u32 v4, v4, v3
v_lshlrev_b32 v4, 4, v4
ds_read_b128 v[132:135], v4 offset:55296
v_add_u32 v4, 128, v1
v_mul_u32_u24 v3, 6, v15
v_sub_u32 v4, v4, v3
v_lshlrev_b32 v4, 4, v4
ds_read_b128 v[136:139], v4 offset:55296
v_mul_u32_u24 v16, 6144, v2
v_add_u32 v16, 110208, v16
v_mul_u32_u24 v17, 96, v1
v_add_u32 v17, v17, v16
v_lshl_add_u32 v16, v1, 2, v16
buffer_load_dwordx4 v[152:155], v6, s[12:15], s29 offen offset:0 nt
buffer_load_dwordx4 v[156:159], v6, s[12:15], s29 offen offset:1024 nt
buffer_load_dwordx4 v[160:163], v6, s[12:15], s29 offen offset:2048 nt
buffer_load_dwordx4 v[164:167], v6, s[12:15], s29 offen offset:3072 nt
s_add_u32 s29, s29, 4096
buffer_load_dwordx4 v[168:171], v6, s[12:15], s29 offen offset:0 nt
buffer_load_dwordx4 v[172:175], v6, s[12:15], s29 offen offset:1024 nt
buffer_load_dwordx4 v[176:179], v6, s[12:15], s29 offen offset:2048 nt
buffer_load_dwordx4 v[180:183], v6, s[12:15], s29 offen offset:3072 nt
s_add_u32 s29, s29, 4096
buffer_load_dwordx4 v[184:187], v6, s[12:15], s29 offen offset:0 nt
buffer_load_dwordx4 v[188:191], v6, s[12:15], s29 offen offset:1024 nt
buffer_load_dwordx4 v[192:195], v6, s[12:15], s29 offen offset:2048 nt
buffer_load_dwordx4 v[196:199], v6, s[12:15], s29 offen offset:3072 nt
s_add_u32 s29, s29, 4096
buffer_load_dwordx4 v[200:203], v6, s[12:15], s29 offen offset:0 nt
buffer_load_dwordx4 v[204:207], v6, s[12:15], s29 offen offset:1024 nt
buffer_load_dwordx4 v[208:211], v6, s[12:15], s29 offen offset:2048 nt
buffer_load_dwordx4 v[212:215], v6, s[12:15], s29 offen offset:3072 nt
s_add_u32 s29, s29, 4096
buffer_load_dwordx4 v[216:219], v6, s[12:15], s29 offen offset:0 nt
buffer_load_dwordx4 v[220:223], v6, s[12:15], s29 offen offset:1024 nt
buffer_load_dwordx4 v[224:227], v6, s[12:15], s29 offen offset:2048 nt
buffer_load_dwordx4 v[228:231], v6, s[12:15], s29 offen offset:3072 nt
s_add_u32 s29, s29, 4096
buffer_load_dwordx4 v[232:235], v6, s[12:15], s29 offen offset:0 nt
buffer_load_dwordx4 v[236:239], v6, s[12:15], s29 offen offset:1024 nt
buffer_load_dwordx4 v[240:243], v6, s[12:15], s29 offen offset:2048 nt
buffer_load_dwordx4 v[244:247], v6, s[12:15], s29 offen offset:3072 nt
s_waitcnt lgkmcnt(0)
s_waitcnt vmcnt(23)
v_dot2_f32_bf16 v20, v152, v128, 0
v_dot2_f32_bf16 v20, v153, v129, v20
v_dot2_f32_bf16 v20, v154, v130, v20
v_dot2_f32_bf16 v20, v155, v131, v20
buffer_load_dwordx4 v[32:35], v6, s[16:19], s30 offen offset:0 nt
buffer_load_dwordx4 v[36:39], v6, s[16:19], s30 offen offset:1024 nt
buffer_load_dwordx4 v[40:43], v6, s[16:19], s30 offen offset:2048 nt
buffer_load_dwordx4 v[44:47], v6, s[16:19], s30 offen offset:3072 nt
s_add_u32 s30, s30, 4096
buffer_load_dwordx4 v[48:51], v6, s[16:19], s30 offen offset:0 nt
buffer_load_dwordx4 v[52:55], v6, s[16:19], s30 offen offset:1024 nt
buffer_load_dwordx4 v[56:59], v6, s[16:19], s30 offen offset:2048 nt
buffer_load_dwordx4 v[60:63], v6, s[16:19], s30 offen offset:3072 nt
s_add_u32 s30, s30, 4096
buffer_load_dwordx4 v[64:67], v6, s[16:19], s30 offen offset:0 nt
buffer_load_dwordx4 v[68:71], v6, s[16:19], s30 offen offset:1024 nt
buffer_load_dwordx4 v[72:75], v6, s[16:19], s30 offen offset:2048 nt
buffer_load_dwordx4 v[76:79], v6, s[16:19], s30 offen offset:3072 nt
s_add_u32 s30, s30, 4096
buffer_load_dwordx4 v[80:83], v6, s[16:19], s30 offen offset:0 nt
buffer_load_dwordx4 v[84:87], v6, s[16:19], s30 offen offset:1024 nt
buffer_load_dwordx4 v[88:91], v6, s[16:19], s30 offen offset:2048 nt
buffer_load_dwordx4 v[92:95], v6, s[16:19], s30 offen offset:3072 nt
s_add_u32 s30, s30, 4096
buffer_load_dwordx4 v[96:99], v6, s[16:19], s30 offen offset:0 nt
buffer_load_dwordx4 v[100:103], v6, s[16:19], s30 offen offset:1024 nt
buffer_load_dwordx4 v[104:107], v6, s[16:19], s30 offen offset:2048 nt
buffer_load_dwordx4 v[108:111], v6, s[16:19], s30 offen offset:3072 nt
s_add_u32 s30, s30, 4096
buffer_load_dwordx4 v[112:115], v6, s[16:19], s30 offen offset:0 nt
buffer_load_dwordx4 v[116:119], v6, s[16:19], s30 offen offset:1024 nt
buffer_load_dwordx4 v[120:123], v6, s[16:19], s30 offen offset:2048 nt
buffer_load_dwordx4 v[124:127], v6, s[16:19], s30 offen offset:3072 nt
s_nop 2
ds_write_b32 v16, v20 offset:0
s_waitcnt vmcnt(46)
v_dot2_f32_bf16 v21, v156, v132, 0
v_dot2_f32_bf16 v21, v157, v133, v21
v_dot2_f32_bf16 v21, v158, v134, v21
v_dot2_f32_bf16 v21, v159, v135, v21
s_nop 2
ds_write_b32 v16, v21 offset:256
s_waitcnt vmcnt(45)
v_dot2_f32_bf16 v22, v160, v136, 0
v_dot2_f32_bf16 v22, v161, v137, v22
v_dot2_f32_bf16 v22, v162, v138, v22
v_dot2_f32_bf16 v22, v163, v139, v22
s_nop 2
ds_write_b32 v16, v22 offset:512
s_waitcnt vmcnt(44)
v_dot2_f32_bf16 v23, v164, v128, 0
v_dot2_f32_bf16 v23, v165, v129, v23
v_dot2_f32_bf16 v23, v166, v130, v23
v_dot2_f32_bf16 v23, v167, v131, v23
s_nop 2
ds_write_b32 v16, v23 offset:768
s_waitcnt vmcnt(43)
v_dot2_f32_bf16 v20, v168, v132, 0
v_dot2_f32_bf16 v20, v169, v133, v20
v_dot2_f32_bf16 v20, v170, v134, v20
v_dot2_f32_bf16 v20, v171, v135, v20
s_nop 2
ds_write_b32 v16, v20 offset:1024
s_waitcnt vmcnt(42)
v_dot2_f32_bf16 v21, v172, v136, 0
v_dot2_f32_bf16 v21, v173, v137, v21
v_dot2_f32_bf16 v21, v174, v138, v21
v_dot2_f32_bf16 v21, v175, v139, v21
s_nop 2
ds_write_b32 v16, v21 offset:1280
s_waitcnt vmcnt(41)
v_dot2_f32_bf16 v22, v176, v128, 0
v_dot2_f32_bf16 v22, v177, v129, v22
v_dot2_f32_bf16 v22, v178, v130, v22
v_dot2_f32_bf16 v22, v179, v131, v22
s_nop 2
ds_write_b32 v16, v22 offset:1536
s_waitcnt vmcnt(40)
v_dot2_f32_bf16 v23, v180, v132, 0
v_dot2_f32_bf16 v23, v181, v133, v23
v_dot2_f32_bf16 v23, v182, v134, v23
v_dot2_f32_bf16 v23, v183, v135, v23
s_nop 2
ds_write_b32 v16, v23 offset:1792
s_waitcnt vmcnt(39)
v_dot2_f32_bf16 v20, v184, v136, 0
v_dot2_f32_bf16 v20, v185, v137, v20
v_dot2_f32_bf16 v20, v186, v138, v20
v_dot2_f32_bf16 v20, v187, v139, v20
s_nop 2
ds_write_b32 v16, v20 offset:2048
s_waitcnt vmcnt(38)
v_dot2_f32_bf16 v21, v188, v128, 0
v_dot2_f32_bf16 v21, v189, v129, v21
v_dot2_f32_bf16 v21, v190, v130, v21
v_dot2_f32_bf16 v21, v191, v131, v21
s_nop 2
ds_write_b32 v16, v21 offset:2304
s_waitcnt vmcnt(37)
v_dot2_f32_bf16 v22, v192, v132, 0
v_dot2_f32_bf16 v22, v193, v133, v22
v_dot2_f32_bf16 v22, v194, v134, v22
v_dot2_f32_bf16 v22, v195, v135, v22
s_nop 2
ds_write_b32 v16, v22 offset:2560
s_waitcnt vmcnt(36)
v_dot2_f32_bf16 v23, v196, v136, 0
v_dot2_f32_bf16 v23, v197, v137, v23
v_dot2_f32_bf16 v23, v198, v138, v23
v_dot2_f32_bf16 v23, v199, v139, v23
s_nop 2
ds_write_b32 v16, v23 offset:2816
s_waitcnt vmcnt(35)
v_dot2_f32_bf16 v20, v200, v128, 0
v_dot2_f32_bf16 v20, v201, v129, v20
v_dot2_f32_bf16 v20, v202, v130, v20
v_dot2_f32_bf16 v20, v203, v131, v20
s_nop 2
ds_write_b32 v16, v20 offset:3072
s_waitcnt vmcnt(34)
v_dot2_f32_bf16 v21, v204, v132, 0
v_dot2_f32_bf16 v21, v205, v133, v21
v_dot2_f32_bf16 v21, v206, v134, v21
v_dot2_f32_bf16 v21, v207, v135, v21
s_nop 2
ds_write_b32 v16, v21 offset:3328
s_waitcnt vmcnt(33)
v_dot2_f32_bf16 v22, v208, v136, 0
v_dot2_f32_bf16 v22, v209, v137, v22
v_dot2_f32_bf16 v22, v210, v138, v22
v_dot2_f32_bf16 v22, v211, v139, v22
s_nop 2
ds_write_b32 v16, v22 offset:3584
s_waitcnt vmcnt(32)
v_dot2_f32_bf16 v23, v212, v128, 0
v_dot2_f32_bf16 v23, v213, v129, v23
v_dot2_f32_bf16 v23, v214, v130, v23
v_dot2_f32_bf16 v23, v215, v131, v23
s_nop 2
ds_write_b32 v16, v23 offset:3840
s_waitcnt vmcnt(31)
v_dot2_f32_bf16 v20, v216, v132, 0
v_dot2_f32_bf16 v20, v217, v133, v20
v_dot2_f32_bf16 v20, v218, v134, v20
v_dot2_f32_bf16 v20, v219, v135, v20
s_nop 2
ds_write_b32 v16, v20 offset:4096
s_waitcnt vmcnt(30)
v_dot2_f32_bf16 v21, v220, v136, 0
v_dot2_f32_bf16 v21, v221, v137, v21
v_dot2_f32_bf16 v21, v222, v138, v21
v_dot2_f32_bf16 v21, v223, v139, v21
s_nop 2
ds_write_b32 v16, v21 offset:4352
s_waitcnt vmcnt(29)
v_dot2_f32_bf16 v22, v224, v128, 0
v_dot2_f32_bf16 v22, v225, v129, v22
v_dot2_f32_bf16 v22, v226, v130, v22
v_dot2_f32_bf16 v22, v227, v131, v22
s_nop 2
ds_write_b32 v16, v22 offset:4608
s_waitcnt vmcnt(28)
v_dot2_f32_bf16 v23, v228, v132, 0
v_dot2_f32_bf16 v23, v229, v133, v23
v_dot2_f32_bf16 v23, v230, v134, v23
v_dot2_f32_bf16 v23, v231, v135, v23
s_nop 2
ds_write_b32 v16, v23 offset:4864
s_waitcnt vmcnt(27)
v_dot2_f32_bf16 v20, v232, v136, 0
v_dot2_f32_bf16 v20, v233, v137, v20
v_dot2_f32_bf16 v20, v234, v138, v20
v_dot2_f32_bf16 v20, v235, v139, v20
s_nop 2
ds_write_b32 v16, v20 offset:5120
s_waitcnt vmcnt(26)
v_dot2_f32_bf16 v21, v236, v128, 0
v_dot2_f32_bf16 v21, v237, v129, v21
v_dot2_f32_bf16 v21, v238, v130, v21
v_dot2_f32_bf16 v21, v239, v131, v21
s_nop 2
ds_write_b32 v16, v21 offset:5376
s_waitcnt vmcnt(25)
v_dot2_f32_bf16 v22, v240, v132, 0
v_dot2_f32_bf16 v22, v241, v133, v22
v_dot2_f32_bf16 v22, v242, v134, v22
v_dot2_f32_bf16 v22, v243, v135, v22
s_nop 2
ds_write_b32 v16, v22 offset:5632
s_waitcnt vmcnt(24)
v_dot2_f32_bf16 v23, v244, v136, 0
v_dot2_f32_bf16 v23, v245, v137, v23
v_dot2_f32_bf16 v23, v246, v138, v23
v_dot2_f32_bf16 v23, v247, v139, v23
s_nop 2
ds_write_b32 v16, v23 offset:5888
s_cmp_ge_u32 s24, 6
s_cbranch_scc1 NO_WO
s_mul_i32 s27, s25, 192
s_mul_i32 s29, s26, 24
s_add_u32 s27, s27, s29
s_mul_i32 s27, s27, 1280
s_mul_i32 s29, s24, 5120
s_add_u32 s27, s27, s29
s_add_u32 s29, s29, 79488
s_mov_b32 m0, s29
s_nop 0
buffer_load_dwordx4 v6, s[52:55], s27 offen nt lds
s_add_u32 s27, s27, 1024
s_add_u32 s29, s29, 1024
s_mov_b32 m0, s29
s_nop 0
buffer_load_dwordx4 v6, s[52:55], s27 offen nt lds
s_add_u32 s27, s27, 1024
s_add_u32 s29, s29, 1024
s_mov_b32 m0, s29
s_nop 0
buffer_load_dwordx4 v6, s[52:55], s27 offen nt lds
s_add_u32 s27, s27, 1024
s_add_u32 s29, s29, 1024
s_mov_b32 m0, s29
s_nop 0
buffer_load_dwordx4 v6, s[52:55], s27 offen nt lds
s_add_u32 s27, s27, 1024
s_add_u32 s29, s29, 1024
s_mov_b32 m0, s29
s_nop 0
buffer_load_dwordx4 v6, s[52:55], s27 offen nt lds
s_add_u32 s27, s27, 1024
s_add_u32 s29, s29, 1024
s_mov_b32 s37, 5
s_branch WO_D
NO_WO:
s_mov_b32 s37, 0
WO_D:
s_waitcnt lgkmcnt(0)
ds_read_b128 v[152:155], v17 offset:0
ds_read_b128 v[156:159], v17 offset:16
ds_read_b128 v[160:163], v17 offset:32
ds_read_b128 v[164:167], v17 offset:48
ds_read_b128 v[168:171], v17 offset:64
ds_read_b128 v[172:175], v17 offset:80
s_mov_b32 s36, 0x3dd53b95
s_waitcnt lgkmcnt(0)
v_add_f32 v152, v152, v153
v_add_f32 v152, v152, v154
v_add_f32 v152, v152, v155
v_add_f32 v152, v152, v156
v_add_f32 v152, v152, v157
v_add_f32 v152, v152, v158
v_add_f32 v152, v152, v159
v_add_f32 v152, v152, v160
v_add_f32 v152, v152, v161
v_add_f32 v152, v152, v162
v_add_f32 v152, v152, v163
v_add_f32 v152, v152, v164
v_add_f32 v152, v152, v165
v_add_f32 v152, v152, v166
v_add_f32 v152, v152, v167
v_add_f32 v152, v152, v168
v_add_f32 v152, v152, v169
v_add_f32 v152, v152, v170
v_add_f32 v152, v152, v171
v_add_f32 v152, v152, v172
v_add_f32 v152, v152, v173
v_add_f32 v152, v152, v174
v_add_f32 v152, v152, v175
v_mov_b32 v252, v152
s_nop 1
v_max_f32_dpp v252, v252, v252 quad_perm:[1,0,3,2] row_mask:0xf bank_mask:0xf
s_nop 1
v_max_f32_dpp v252, v252, v252 quad_perm:[2,3,0,1] row_mask:0xf bank_mask:0xf
s_nop 1
v_max_f32_dpp v252, v252, v252 row_half_mirror row_mask:0xf bank_mask:0xf
s_nop 1
v_max_f32_dpp v252, v252, v252 row_mirror row_mask:0xf bank_mask:0xf
s_nop 1
v_max_f32_dpp v252, v252, v252 row_bcast:15 row_mask:0xa bank_mask:0xf
s_nop 1
v_max_f32_dpp v252, v252, v252 row_bcast:31 row_mask:0xc bank_mask:0xf
s_nop 1
v_readlane_b32 s32, v252, 63
s_nop 3
v_mov_b32 v252, s32
v_mul_f32 v254, s36, v252
v_fma_f32 v152, v152, s36, -v254
v_exp_f32 v152, v152
s_nop 0
v_mov_b32 v253, v152
s_nop 1
v_add_f32_dpp v253, v253, v253 quad_perm:[1,0,3,2] row_mask:0xf bank_mask:0xf
s_nop 1
v_add_f32_dpp v253, v253, v253 quad_perm:[2,3,0,1] row_mask:0xf bank_mask:0xf
s_nop 1
v_add_f32_dpp v253, v253, v253 row_half_mirror row_mask:0xf bank_mask:0xf
s_nop 1
v_add_f32_dpp v253, v253, v253 row_mirror row_mask:0xf bank_mask:0xf
s_nop 1
v_add_f32_dpp v253, v253, v253 row_bcast:15 row_mask:0xa bank_mask:0xf
s_nop 1
v_add_f32_dpp v253, v253, v253 row_bcast:31 row_mask:0xc bank_mask:0xf
s_nop 1
v_readlane_b32 s33, v253, 63
s_nop 3
v_mov_b32 v253, s33
v_lshlrev_b32 v7, 8, v2
v_add_u32 v7, 55936, v7
v_lshl_add_u32 v4, v1, 2, v7
ds_write_b32 v4, v152
v_lshlrev_b32 v4, 3, v2
ds_write_b64 v4, v[252:253] offset:55808
s_waitcnt lgkmcnt(0)
v_add_u32 v4, v7, v13
ds_read2_b32 v[152:153], v4 offset0:0 offset1:8
ds_read2_b32 v[154:155], v4 offset0:16 offset1:24
ds_read2_b32 v[156:157], v4 offset0:32 offset1:40
ds_read2_b32 v[158:159], v4 offset0:48 offset1:56
v_add_u32 v4, v7, v14
ds_read2_b32 v[160:161], v4 offset0:0 offset1:8
ds_read2_b32 v[162:163], v4 offset0:16 offset1:24
ds_read2_b32 v[164:165], v4 offset0:32 offset1:40
ds_read2_b32 v[166:167], v4 offset0:48 offset1:56
v_add_u32 v4, v7, v15
ds_read2_b32 v[168:169], v4 offset0:0 offset1:8
ds_read2_b32 v[170:171], v4 offset0:16 offset1:24
ds_read2_b32 v[172:173], v4 offset0:32 offset1:40
ds_read2_b32 v[174:175], v4 offset0:48 offset1:56
v_mov_b32 v176, 0
v_mov_b32 v177, 0
v_mov_b32 v178, 0
v_mov_b32 v179, 0
v_mov_b32 v180, 0
v_mov_b32 v181, 0
v_mov_b32 v182, 0
v_mov_b32 v183, 0
v_mov_b32 v184, 0
v_mov_b32 v185, 0
v_mov_b32 v186, 0
v_mov_b32 v187, 0
v_mov_b32 v188, 0
v_mov_b32 v189, 0
v_mov_b32 v190, 0
v_mov_b32 v191, 0
v_mov_b32 v192, 0
v_mov_b32 v193, 0
v_mov_b32 v194, 0
v_mov_b32 v195, 0
v_mov_b32 v196, 0
v_mov_b32 v197, 0
v_mov_b32 v198, 0
v_mov_b32 v199, 0
s_waitcnt lgkmcnt(0)
s_cmp_eq_u32 s37, 0
s_cbranch_scc1 PV_B
s_waitcnt vmcnt(28)
v_lshlrev_b32 v3, 16, v32
v_and_b32 v4, 0xffff0000, v32
v_fmac_f32 v176, v3, v152
v_fmac_f32 v177, v4, v152
v_lshlrev_b32 v3, 16, v33
v_and_b32 v4, 0xffff0000, v33
v_fmac_f32 v178, v3, v152
v_fmac_f32 v179, v4, v152
v_lshlrev_b32 v3, 16, v34
v_and_b32 v4, 0xffff0000, v34
v_fmac_f32 v180, v3, v152
v_fmac_f32 v181, v4, v152
v_lshlrev_b32 v3, 16, v35
v_and_b32 v4, 0xffff0000, v35
v_fmac_f32 v182, v3, v152
v_fmac_f32 v183, v4, v152
s_waitcnt vmcnt(27)
v_lshlrev_b32 v3, 16, v36
v_and_b32 v4, 0xffff0000, v36
v_fmac_f32 v184, v3, v160
v_fmac_f32 v185, v4, v160
v_lshlrev_b32 v3, 16, v37
v_and_b32 v4, 0xffff0000, v37
v_fmac_f32 v186, v3, v160
v_fmac_f32 v187, v4, v160
v_lshlrev_b32 v3, 16, v38
v_and_b32 v4, 0xffff0000, v38
v_fmac_f32 v188, v3, v160
v_fmac_f32 v189, v4, v160
v_lshlrev_b32 v3, 16, v39
v_and_b32 v4, 0xffff0000, v39
v_fmac_f32 v190, v3, v160
v_fmac_f32 v191, v4, v160
s_waitcnt vmcnt(26)
v_lshlrev_b32 v3, 16, v40
v_and_b32 v4, 0xffff0000, v40
v_fmac_f32 v192, v3, v168
v_fmac_f32 v193, v4, v168
v_lshlrev_b32 v3, 16, v41
v_and_b32 v4, 0xffff0000, v41
v_fmac_f32 v194, v3, v168
v_fmac_f32 v195, v4, v168
v_lshlrev_b32 v3, 16, v42
v_and_b32 v4, 0xffff0000, v42
v_fmac_f32 v196, v3, v168
v_fmac_f32 v197, v4, v168
v_lshlrev_b32 v3, 16, v43
v_and_b32 v4, 0xffff0000, v43
v_fmac_f32 v198, v3, v168
v_fmac_f32 v199, v4, v168
s_waitcnt vmcnt(25)
v_lshlrev_b32 v3, 16, v44
v_and_b32 v4, 0xffff0000, v44
v_fmac_f32 v176, v3, v153
v_fmac_f32 v177, v4, v153
v_lshlrev_b32 v3, 16, v45
v_and_b32 v4, 0xffff0000, v45
v_fmac_f32 v178, v3, v153
v_fmac_f32 v179, v4, v153
v_lshlrev_b32 v3, 16, v46
v_and_b32 v4, 0xffff0000, v46
v_fmac_f32 v180, v3, v153
v_fmac_f32 v181, v4, v153
v_lshlrev_b32 v3, 16, v47
v_and_b32 v4, 0xffff0000, v47
v_fmac_f32 v182, v3, v153
v_fmac_f32 v183, v4, v153
s_waitcnt vmcnt(24)
v_lshlrev_b32 v3, 16, v48
v_and_b32 v4, 0xffff0000, v48
v_fmac_f32 v184, v3, v161
v_fmac_f32 v185, v4, v161
v_lshlrev_b32 v3, 16, v49
v_and_b32 v4, 0xffff0000, v49
v_fmac_f32 v186, v3, v161
v_fmac_f32 v187, v4, v161
v_lshlrev_b32 v3, 16, v50
v_and_b32 v4, 0xffff0000, v50
v_fmac_f32 v188, v3, v161
v_fmac_f32 v189, v4, v161
v_lshlrev_b32 v3, 16, v51
v_and_b32 v4, 0xffff0000, v51
v_fmac_f32 v190, v3, v161
v_fmac_f32 v191, v4, v161
s_waitcnt vmcnt(23)
v_lshlrev_b32 v3, 16, v52
v_and_b32 v4, 0xffff0000, v52
v_fmac_f32 v192, v3, v169
v_fmac_f32 v193, v4, v169
v_lshlrev_b32 v3, 16, v53
v_and_b32 v4, 0xffff0000, v53
v_fmac_f32 v194, v3, v169
v_fmac_f32 v195, v4, v169
v_lshlrev_b32 v3, 16, v54
v_and_b32 v4, 0xffff0000, v54
v_fmac_f32 v196, v3, v169
v_fmac_f32 v197, v4, v169
v_lshlrev_b32 v3, 16, v55
v_and_b32 v4, 0xffff0000, v55
v_fmac_f32 v198, v3, v169
v_fmac_f32 v199, v4, v169
s_waitcnt vmcnt(22)
v_lshlrev_b32 v3, 16, v56
v_and_b32 v4, 0xffff0000, v56
v_fmac_f32 v176, v3, v154
v_fmac_f32 v177, v4, v154
v_lshlrev_b32 v3, 16, v57
v_and_b32 v4, 0xffff0000, v57
v_fmac_f32 v178, v3, v154
v_fmac_f32 v179, v4, v154
v_lshlrev_b32 v3, 16, v58
v_and_b32 v4, 0xffff0000, v58
v_fmac_f32 v180, v3, v154
v_fmac_f32 v181, v4, v154
v_lshlrev_b32 v3, 16, v59
v_and_b32 v4, 0xffff0000, v59
v_fmac_f32 v182, v3, v154
v_fmac_f32 v183, v4, v154
s_waitcnt vmcnt(21)
v_lshlrev_b32 v3, 16, v60
v_and_b32 v4, 0xffff0000, v60
v_fmac_f32 v184, v3, v162
v_fmac_f32 v185, v4, v162
v_lshlrev_b32 v3, 16, v61
v_and_b32 v4, 0xffff0000, v61
v_fmac_f32 v186, v3, v162
v_fmac_f32 v187, v4, v162
v_lshlrev_b32 v3, 16, v62
v_and_b32 v4, 0xffff0000, v62
v_fmac_f32 v188, v3, v162
v_fmac_f32 v189, v4, v162
v_lshlrev_b32 v3, 16, v63
v_and_b32 v4, 0xffff0000, v63
v_fmac_f32 v190, v3, v162
v_fmac_f32 v191, v4, v162
s_waitcnt vmcnt(20)
v_lshlrev_b32 v3, 16, v64
v_and_b32 v4, 0xffff0000, v64
v_fmac_f32 v192, v3, v170
v_fmac_f32 v193, v4, v170
v_lshlrev_b32 v3, 16, v65
v_and_b32 v4, 0xffff0000, v65
v_fmac_f32 v194, v3, v170
v_fmac_f32 v195, v4, v170
v_lshlrev_b32 v3, 16, v66
v_and_b32 v4, 0xffff0000, v66
v_fmac_f32 v196, v3, v170
v_fmac_f32 v197, v4, v170
v_lshlrev_b32 v3, 16, v67
v_and_b32 v4, 0xffff0000, v67
v_fmac_f32 v198, v3, v170
v_fmac_f32 v199, v4, v170
s_waitcnt vmcnt(19)
v_lshlrev_b32 v3, 16, v68
v_and_b32 v4, 0xffff0000, v68
v_fmac_f32 v176, v3, v155
v_fmac_f32 v177, v4, v155
v_lshlrev_b32 v3, 16, v69
v_and_b32 v4, 0xffff0000, v69
v_fmac_f32 v178, v3, v155
v_fmac_f32 v179, v4, v155
v_lshlrev_b32 v3, 16, v70
v_and_b32 v4, 0xffff0000, v70
v_fmac_f32 v180, v3, v155
v_fmac_f32 v181, v4, v155
v_lshlrev_b32 v3, 16, v71
v_and_b32 v4, 0xffff0000, v71
v_fmac_f32 v182, v3, v155
v_fmac_f32 v183, v4, v155
s_waitcnt vmcnt(18)
v_lshlrev_b32 v3, 16, v72
v_and_b32 v4, 0xffff0000, v72
v_fmac_f32 v184, v3, v163
v_fmac_f32 v185, v4, v163
v_lshlrev_b32 v3, 16, v73
v_and_b32 v4, 0xffff0000, v73
v_fmac_f32 v186, v3, v163
v_fmac_f32 v187, v4, v163
v_lshlrev_b32 v3, 16, v74
v_and_b32 v4, 0xffff0000, v74
v_fmac_f32 v188, v3, v163
v_fmac_f32 v189, v4, v163
v_lshlrev_b32 v3, 16, v75
v_and_b32 v4, 0xffff0000, v75
v_fmac_f32 v190, v3, v163
v_fmac_f32 v191, v4, v163
s_waitcnt vmcnt(17)
v_lshlrev_b32 v3, 16, v76
v_and_b32 v4, 0xffff0000, v76
v_fmac_f32 v192, v3, v171
v_fmac_f32 v193, v4, v171
v_lshlrev_b32 v3, 16, v77
v_and_b32 v4, 0xffff0000, v77
v_fmac_f32 v194, v3, v171
v_fmac_f32 v195, v4, v171
v_lshlrev_b32 v3, 16, v78
v_and_b32 v4, 0xffff0000, v78
v_fmac_f32 v196, v3, v171
v_fmac_f32 v197, v4, v171
v_lshlrev_b32 v3, 16, v79
v_and_b32 v4, 0xffff0000, v79
v_fmac_f32 v198, v3, v171
v_fmac_f32 v199, v4, v171
s_waitcnt vmcnt(16)
v_lshlrev_b32 v3, 16, v80
v_and_b32 v4, 0xffff0000, v80
v_fmac_f32 v176, v3, v156
v_fmac_f32 v177, v4, v156
v_lshlrev_b32 v3, 16, v81
v_and_b32 v4, 0xffff0000, v81
v_fmac_f32 v178, v3, v156
v_fmac_f32 v179, v4, v156
v_lshlrev_b32 v3, 16, v82
v_and_b32 v4, 0xffff0000, v82
v_fmac_f32 v180, v3, v156
v_fmac_f32 v181, v4, v156
v_lshlrev_b32 v3, 16, v83
v_and_b32 v4, 0xffff0000, v83
v_fmac_f32 v182, v3, v156
v_fmac_f32 v183, v4, v156
s_waitcnt vmcnt(15)
v_lshlrev_b32 v3, 16, v84
v_and_b32 v4, 0xffff0000, v84
v_fmac_f32 v184, v3, v164
v_fmac_f32 v185, v4, v164
v_lshlrev_b32 v3, 16, v85
v_and_b32 v4, 0xffff0000, v85
v_fmac_f32 v186, v3, v164
v_fmac_f32 v187, v4, v164
v_lshlrev_b32 v3, 16, v86
v_and_b32 v4, 0xffff0000, v86
v_fmac_f32 v188, v3, v164
v_fmac_f32 v189, v4, v164
v_lshlrev_b32 v3, 16, v87
v_and_b32 v4, 0xffff0000, v87
v_fmac_f32 v190, v3, v164
v_fmac_f32 v191, v4, v164
s_waitcnt vmcnt(14)
v_lshlrev_b32 v3, 16, v88
v_and_b32 v4, 0xffff0000, v88
v_fmac_f32 v192, v3, v172
v_fmac_f32 v193, v4, v172
v_lshlrev_b32 v3, 16, v89
v_and_b32 v4, 0xffff0000, v89
v_fmac_f32 v194, v3, v172
v_fmac_f32 v195, v4, v172
v_lshlrev_b32 v3, 16, v90
v_and_b32 v4, 0xffff0000, v90
v_fmac_f32 v196, v3, v172
v_fmac_f32 v197, v4, v172
v_lshlrev_b32 v3, 16, v91
v_and_b32 v4, 0xffff0000, v91
v_fmac_f32 v198, v3, v172
v_fmac_f32 v199, v4, v172
s_waitcnt vmcnt(13)
v_lshlrev_b32 v3, 16, v92
v_and_b32 v4, 0xffff0000, v92
v_fmac_f32 v176, v3, v157
v_fmac_f32 v177, v4, v157
v_lshlrev_b32 v3, 16, v93
v_and_b32 v4, 0xffff0000, v93
v_fmac_f32 v178, v3, v157
v_fmac_f32 v179, v4, v157
v_lshlrev_b32 v3, 16, v94
v_and_b32 v4, 0xffff0000, v94
v_fmac_f32 v180, v3, v157
v_fmac_f32 v181, v4, v157
v_lshlrev_b32 v3, 16, v95
v_and_b32 v4, 0xffff0000, v95
v_fmac_f32 v182, v3, v157
v_fmac_f32 v183, v4, v157
s_waitcnt vmcnt(12)
v_lshlrev_b32 v3, 16, v96
v_and_b32 v4, 0xffff0000, v96
v_fmac_f32 v184, v3, v165
v_fmac_f32 v185, v4, v165
v_lshlrev_b32 v3, 16, v97
v_and_b32 v4, 0xffff0000, v97
v_fmac_f32 v186, v3, v165
v_fmac_f32 v187, v4, v165
v_lshlrev_b32 v3, 16, v98
v_and_b32 v4, 0xffff0000, v98
v_fmac_f32 v188, v3, v165
v_fmac_f32 v189, v4, v165
v_lshlrev_b32 v3, 16, v99
v_and_b32 v4, 0xffff0000, v99
v_fmac_f32 v190, v3, v165
v_fmac_f32 v191, v4, v165
s_waitcnt vmcnt(11)
v_lshlrev_b32 v3, 16, v100
v_and_b32 v4, 0xffff0000, v100
v_fmac_f32 v192, v3, v173
v_fmac_f32 v193, v4, v173
v_lshlrev_b32 v3, 16, v101
v_and_b32 v4, 0xffff0000, v101
v_fmac_f32 v194, v3, v173
v_fmac_f32 v195, v4, v173
v_lshlrev_b32 v3, 16, v102
v_and_b32 v4, 0xffff0000, v102
v_fmac_f32 v196, v3, v173
v_fmac_f32 v197, v4, v173
v_lshlrev_b32 v3, 16, v103
v_and_b32 v4, 0xffff0000, v103
v_fmac_f32 v198, v3, v173
v_fmac_f32 v199, v4, v173
s_waitcnt vmcnt(10)
v_lshlrev_b32 v3, 16, v104
v_and_b32 v4, 0xffff0000, v104
v_fmac_f32 v176, v3, v158
v_fmac_f32 v177, v4, v158
v_lshlrev_b32 v3, 16, v105
v_and_b32 v4, 0xffff0000, v105
v_fmac_f32 v178, v3, v158
v_fmac_f32 v179, v4, v158
v_lshlrev_b32 v3, 16, v106
v_and_b32 v4, 0xffff0000, v106
v_fmac_f32 v180, v3, v158
v_fmac_f32 v181, v4, v158
v_lshlrev_b32 v3, 16, v107
v_and_b32 v4, 0xffff0000, v107
v_fmac_f32 v182, v3, v158
v_fmac_f32 v183, v4, v158
s_waitcnt vmcnt(9)
v_lshlrev_b32 v3, 16, v108
v_and_b32 v4, 0xffff0000, v108
v_fmac_f32 v184, v3, v166
v_fmac_f32 v185, v4, v166
v_lshlrev_b32 v3, 16, v109
v_and_b32 v4, 0xffff0000, v109
v_fmac_f32 v186, v3, v166
v_fmac_f32 v187, v4, v166
v_lshlrev_b32 v3, 16, v110
v_and_b32 v4, 0xffff0000, v110
v_fmac_f32 v188, v3, v166
v_fmac_f32 v189, v4, v166
v_lshlrev_b32 v3, 16, v111
v_and_b32 v4, 0xffff0000, v111
v_fmac_f32 v190, v3, v166
v_fmac_f32 v191, v4, v166
s_waitcnt vmcnt(8)
v_lshlrev_b32 v3, 16, v112
v_and_b32 v4, 0xffff0000, v112
v_fmac_f32 v192, v3, v174
v_fmac_f32 v193, v4, v174
v_lshlrev_b32 v3, 16, v113
v_and_b32 v4, 0xffff0000, v113
v_fmac_f32 v194, v3, v174
v_fmac_f32 v195, v4, v174
v_lshlrev_b32 v3, 16, v114
v_and_b32 v4, 0xffff0000, v114
v_fmac_f32 v196, v3, v174
v_fmac_f32 v197, v4, v174
v_lshlrev_b32 v3, 16, v115
v_and_b32 v4, 0xffff0000, v115
v_fmac_f32 v198, v3, v174
v_fmac_f32 v199, v4, v174
s_waitcnt vmcnt(7)
v_lshlrev_b32 v3, 16, v116
v_and_b32 v4, 0xffff0000, v116
v_fmac_f32 v176, v3, v159
v_fmac_f32 v177, v4, v159
v_lshlrev_b32 v3, 16, v117
v_and_b32 v4, 0xffff0000, v117
v_fmac_f32 v178, v3, v159
v_fmac_f32 v179, v4, v159
v_lshlrev_b32 v3, 16, v118
v_and_b32 v4, 0xffff0000, v118
v_fmac_f32 v180, v3, v159
v_fmac_f32 v181, v4, v159
v_lshlrev_b32 v3, 16, v119
v_and_b32 v4, 0xffff0000, v119
v_fmac_f32 v182, v3, v159
v_fmac_f32 v183, v4, v159
s_waitcnt vmcnt(6)
v_lshlrev_b32 v3, 16, v120
v_and_b32 v4, 0xffff0000, v120
v_fmac_f32 v184, v3, v167
v_fmac_f32 v185, v4, v167
v_lshlrev_b32 v3, 16, v121
v_and_b32 v4, 0xffff0000, v121
v_fmac_f32 v186, v3, v167
v_fmac_f32 v187, v4, v167
v_lshlrev_b32 v3, 16, v122
v_and_b32 v4, 0xffff0000, v122
v_fmac_f32 v188, v3, v167
v_fmac_f32 v189, v4, v167
v_lshlrev_b32 v3, 16, v123
v_and_b32 v4, 0xffff0000, v123
v_fmac_f32 v190, v3, v167
v_fmac_f32 v191, v4, v167
s_waitcnt vmcnt(5)
v_lshlrev_b32 v3, 16, v124
v_and_b32 v4, 0xffff0000, v124
v_fmac_f32 v192, v3, v175
v_fmac_f32 v193, v4, v175
v_lshlrev_b32 v3, 16, v125
v_and_b32 v4, 0xffff0000, v125
v_fmac_f32 v194, v3, v175
v_fmac_f32 v195, v4, v175
v_lshlrev_b32 v3, 16, v126
v_and_b32 v4, 0xffff0000, v126
v_fmac_f32 v196, v3, v175
v_fmac_f32 v197, v4, v175
v_lshlrev_b32 v3, 16, v127
v_and_b32 v4, 0xffff0000, v127
v_fmac_f32 v198, v3, v175
v_fmac_f32 v199, v4, v175
s_branch PV_D
PV_B:
s_waitcnt vmcnt(23)
v_lshlrev_b32 v3, 16, v32
v_and_b32 v4, 0xffff0000, v32
v_fmac_f32 v176, v3, v152
v_fmac_f32 v177, v4, v152
v_lshlrev_b32 v3, 16, v33
v_and_b32 v4, 0xffff0000, v33
v_fmac_f32 v178, v3, v152
v_fmac_f32 v179, v4, v152
v_lshlrev_b32 v3, 16, v34
v_and_b32 v4, 0xffff0000, v34
v_fmac_f32 v180, v3, v152
v_fmac_f32 v181, v4, v152
v_lshlrev_b32 v3, 16, v35
v_and_b32 v4, 0xffff0000, v35
v_fmac_f32 v182, v3, v152
v_fmac_f32 v183, v4, v152
s_waitcnt vmcnt(22)
v_lshlrev_b32 v3, 16, v36
v_and_b32 v4, 0xffff0000, v36
v_fmac_f32 v184, v3, v160
v_fmac_f32 v185, v4, v160
v_lshlrev_b32 v3, 16, v37
v_and_b32 v4, 0xffff0000, v37
v_fmac_f32 v186, v3, v160
v_fmac_f32 v187, v4, v160
v_lshlrev_b32 v3, 16, v38
v_and_b32 v4, 0xffff0000, v38
v_fmac_f32 v188, v3, v160
v_fmac_f32 v189, v4, v160
v_lshlrev_b32 v3, 16, v39
v_and_b32 v4, 0xffff0000, v39
v_fmac_f32 v190, v3, v160
v_fmac_f32 v191, v4, v160
s_waitcnt vmcnt(21)
v_lshlrev_b32 v3, 16, v40
v_and_b32 v4, 0xffff0000, v40
v_fmac_f32 v192, v3, v168
v_fmac_f32 v193, v4, v168
v_lshlrev_b32 v3, 16, v41
v_and_b32 v4, 0xffff0000, v41
v_fmac_f32 v194, v3, v168
v_fmac_f32 v195, v4, v168
v_lshlrev_b32 v3, 16, v42
v_and_b32 v4, 0xffff0000, v42
v_fmac_f32 v196, v3, v168
v_fmac_f32 v197, v4, v168
v_lshlrev_b32 v3, 16, v43
v_and_b32 v4, 0xffff0000, v43
v_fmac_f32 v198, v3, v168
v_fmac_f32 v199, v4, v168
s_waitcnt vmcnt(20)
v_lshlrev_b32 v3, 16, v44
v_and_b32 v4, 0xffff0000, v44
v_fmac_f32 v176, v3, v153
v_fmac_f32 v177, v4, v153
v_lshlrev_b32 v3, 16, v45
v_and_b32 v4, 0xffff0000, v45
v_fmac_f32 v178, v3, v153
v_fmac_f32 v179, v4, v153
v_lshlrev_b32 v3, 16, v46
v_and_b32 v4, 0xffff0000, v46
v_fmac_f32 v180, v3, v153
v_fmac_f32 v181, v4, v153
v_lshlrev_b32 v3, 16, v47
v_and_b32 v4, 0xffff0000, v47
v_fmac_f32 v182, v3, v153
v_fmac_f32 v183, v4, v153
s_waitcnt vmcnt(19)
v_lshlrev_b32 v3, 16, v48
v_and_b32 v4, 0xffff0000, v48
v_fmac_f32 v184, v3, v161
v_fmac_f32 v185, v4, v161
v_lshlrev_b32 v3, 16, v49
v_and_b32 v4, 0xffff0000, v49
v_fmac_f32 v186, v3, v161
v_fmac_f32 v187, v4, v161
v_lshlrev_b32 v3, 16, v50
v_and_b32 v4, 0xffff0000, v50
v_fmac_f32 v188, v3, v161
v_fmac_f32 v189, v4, v161
v_lshlrev_b32 v3, 16, v51
v_and_b32 v4, 0xffff0000, v51
v_fmac_f32 v190, v3, v161
v_fmac_f32 v191, v4, v161
s_waitcnt vmcnt(18)
v_lshlrev_b32 v3, 16, v52
v_and_b32 v4, 0xffff0000, v52
v_fmac_f32 v192, v3, v169
v_fmac_f32 v193, v4, v169
v_lshlrev_b32 v3, 16, v53
v_and_b32 v4, 0xffff0000, v53
v_fmac_f32 v194, v3, v169
v_fmac_f32 v195, v4, v169
v_lshlrev_b32 v3, 16, v54
v_and_b32 v4, 0xffff0000, v54
v_fmac_f32 v196, v3, v169
v_fmac_f32 v197, v4, v169
v_lshlrev_b32 v3, 16, v55
v_and_b32 v4, 0xffff0000, v55
v_fmac_f32 v198, v3, v169
v_fmac_f32 v199, v4, v169
s_waitcnt vmcnt(17)
v_lshlrev_b32 v3, 16, v56
v_and_b32 v4, 0xffff0000, v56
v_fmac_f32 v176, v3, v154
v_fmac_f32 v177, v4, v154
v_lshlrev_b32 v3, 16, v57
v_and_b32 v4, 0xffff0000, v57
v_fmac_f32 v178, v3, v154
v_fmac_f32 v179, v4, v154
v_lshlrev_b32 v3, 16, v58
v_and_b32 v4, 0xffff0000, v58
v_fmac_f32 v180, v3, v154
v_fmac_f32 v181, v4, v154
v_lshlrev_b32 v3, 16, v59
v_and_b32 v4, 0xffff0000, v59
v_fmac_f32 v182, v3, v154
v_fmac_f32 v183, v4, v154
s_waitcnt vmcnt(16)
v_lshlrev_b32 v3, 16, v60
v_and_b32 v4, 0xffff0000, v60
v_fmac_f32 v184, v3, v162
v_fmac_f32 v185, v4, v162
v_lshlrev_b32 v3, 16, v61
v_and_b32 v4, 0xffff0000, v61
v_fmac_f32 v186, v3, v162
v_fmac_f32 v187, v4, v162
v_lshlrev_b32 v3, 16, v62
v_and_b32 v4, 0xffff0000, v62
v_fmac_f32 v188, v3, v162
v_fmac_f32 v189, v4, v162
v_lshlrev_b32 v3, 16, v63
v_and_b32 v4, 0xffff0000, v63
v_fmac_f32 v190, v3, v162
v_fmac_f32 v191, v4, v162
s_waitcnt vmcnt(15)
v_lshlrev_b32 v3, 16, v64
v_and_b32 v4, 0xffff0000, v64
v_fmac_f32 v192, v3, v170
v_fmac_f32 v193, v4, v170
v_lshlrev_b32 v3, 16, v65
v_and_b32 v4, 0xffff0000, v65
v_fmac_f32 v194, v3, v170
v_fmac_f32 v195, v4, v170
v_lshlrev_b32 v3, 16, v66
v_and_b32 v4, 0xffff0000, v66
v_fmac_f32 v196, v3, v170
v_fmac_f32 v197, v4, v170
v_lshlrev_b32 v3, 16, v67
v_and_b32 v4, 0xffff0000, v67
v_fmac_f32 v198, v3, v170
v_fmac_f32 v199, v4, v170
s_waitcnt vmcnt(14)
v_lshlrev_b32 v3, 16, v68
v_and_b32 v4, 0xffff0000, v68
v_fmac_f32 v176, v3, v155
v_fmac_f32 v177, v4, v155
v_lshlrev_b32 v3, 16, v69
v_and_b32 v4, 0xffff0000, v69
v_fmac_f32 v178, v3, v155
v_fmac_f32 v179, v4, v155
v_lshlrev_b32 v3, 16, v70
v_and_b32 v4, 0xffff0000, v70
v_fmac_f32 v180, v3, v155
v_fmac_f32 v181, v4, v155
v_lshlrev_b32 v3, 16, v71
v_and_b32 v4, 0xffff0000, v71
v_fmac_f32 v182, v3, v155
v_fmac_f32 v183, v4, v155
s_waitcnt vmcnt(13)
v_lshlrev_b32 v3, 16, v72
v_and_b32 v4, 0xffff0000, v72
v_fmac_f32 v184, v3, v163
v_fmac_f32 v185, v4, v163
v_lshlrev_b32 v3, 16, v73
v_and_b32 v4, 0xffff0000, v73
v_fmac_f32 v186, v3, v163
v_fmac_f32 v187, v4, v163
v_lshlrev_b32 v3, 16, v74
v_and_b32 v4, 0xffff0000, v74
v_fmac_f32 v188, v3, v163
v_fmac_f32 v189, v4, v163
v_lshlrev_b32 v3, 16, v75
v_and_b32 v4, 0xffff0000, v75
v_fmac_f32 v190, v3, v163
v_fmac_f32 v191, v4, v163
s_waitcnt vmcnt(12)
v_lshlrev_b32 v3, 16, v76
v_and_b32 v4, 0xffff0000, v76
v_fmac_f32 v192, v3, v171
v_fmac_f32 v193, v4, v171
v_lshlrev_b32 v3, 16, v77
v_and_b32 v4, 0xffff0000, v77
v_fmac_f32 v194, v3, v171
v_fmac_f32 v195, v4, v171
v_lshlrev_b32 v3, 16, v78
v_and_b32 v4, 0xffff0000, v78
v_fmac_f32 v196, v3, v171
v_fmac_f32 v197, v4, v171
v_lshlrev_b32 v3, 16, v79
v_and_b32 v4, 0xffff0000, v79
v_fmac_f32 v198, v3, v171
v_fmac_f32 v199, v4, v171
s_waitcnt vmcnt(11)
v_lshlrev_b32 v3, 16, v80
v_and_b32 v4, 0xffff0000, v80
v_fmac_f32 v176, v3, v156
v_fmac_f32 v177, v4, v156
v_lshlrev_b32 v3, 16, v81
v_and_b32 v4, 0xffff0000, v81
v_fmac_f32 v178, v3, v156
v_fmac_f32 v179, v4, v156
v_lshlrev_b32 v3, 16, v82
v_and_b32 v4, 0xffff0000, v82
v_fmac_f32 v180, v3, v156
v_fmac_f32 v181, v4, v156
v_lshlrev_b32 v3, 16, v83
v_and_b32 v4, 0xffff0000, v83
v_fmac_f32 v182, v3, v156
v_fmac_f32 v183, v4, v156
s_waitcnt vmcnt(10)
v_lshlrev_b32 v3, 16, v84
v_and_b32 v4, 0xffff0000, v84
v_fmac_f32 v184, v3, v164
v_fmac_f32 v185, v4, v164
v_lshlrev_b32 v3, 16, v85
v_and_b32 v4, 0xffff0000, v85
v_fmac_f32 v186, v3, v164
v_fmac_f32 v187, v4, v164
v_lshlrev_b32 v3, 16, v86
v_and_b32 v4, 0xffff0000, v86
v_fmac_f32 v188, v3, v164
v_fmac_f32 v189, v4, v164
v_lshlrev_b32 v3, 16, v87
v_and_b32 v4, 0xffff0000, v87
v_fmac_f32 v190, v3, v164
v_fmac_f32 v191, v4, v164
s_waitcnt vmcnt(9)
v_lshlrev_b32 v3, 16, v88
v_and_b32 v4, 0xffff0000, v88
v_fmac_f32 v192, v3, v172
v_fmac_f32 v193, v4, v172
v_lshlrev_b32 v3, 16, v89
v_and_b32 v4, 0xffff0000, v89
v_fmac_f32 v194, v3, v172
v_fmac_f32 v195, v4, v172
v_lshlrev_b32 v3, 16, v90
v_and_b32 v4, 0xffff0000, v90
v_fmac_f32 v196, v3, v172
v_fmac_f32 v197, v4, v172
v_lshlrev_b32 v3, 16, v91
v_and_b32 v4, 0xffff0000, v91
v_fmac_f32 v198, v3, v172
v_fmac_f32 v199, v4, v172
s_waitcnt vmcnt(8)
v_lshlrev_b32 v3, 16, v92
v_and_b32 v4, 0xffff0000, v92
v_fmac_f32 v176, v3, v157
v_fmac_f32 v177, v4, v157
v_lshlrev_b32 v3, 16, v93
v_and_b32 v4, 0xffff0000, v93
v_fmac_f32 v178, v3, v157
v_fmac_f32 v179, v4, v157
v_lshlrev_b32 v3, 16, v94
v_and_b32 v4, 0xffff0000, v94
v_fmac_f32 v180, v3, v157
v_fmac_f32 v181, v4, v157
v_lshlrev_b32 v3, 16, v95
v_and_b32 v4, 0xffff0000, v95
v_fmac_f32 v182, v3, v157
v_fmac_f32 v183, v4, v157
s_waitcnt vmcnt(7)
v_lshlrev_b32 v3, 16, v96
v_and_b32 v4, 0xffff0000, v96
v_fmac_f32 v184, v3, v165
v_fmac_f32 v185, v4, v165
v_lshlrev_b32 v3, 16, v97
v_and_b32 v4, 0xffff0000, v97
v_fmac_f32 v186, v3, v165
v_fmac_f32 v187, v4, v165
v_lshlrev_b32 v3, 16, v98
v_and_b32 v4, 0xffff0000, v98
v_fmac_f32 v188, v3, v165
v_fmac_f32 v189, v4, v165
v_lshlrev_b32 v3, 16, v99
v_and_b32 v4, 0xffff0000, v99
v_fmac_f32 v190, v3, v165
v_fmac_f32 v191, v4, v165
s_waitcnt vmcnt(6)
v_lshlrev_b32 v3, 16, v100
v_and_b32 v4, 0xffff0000, v100
v_fmac_f32 v192, v3, v173
v_fmac_f32 v193, v4, v173
v_lshlrev_b32 v3, 16, v101
v_and_b32 v4, 0xffff0000, v101
v_fmac_f32 v194, v3, v173
v_fmac_f32 v195, v4, v173
v_lshlrev_b32 v3, 16, v102
v_and_b32 v4, 0xffff0000, v102
v_fmac_f32 v196, v3, v173
v_fmac_f32 v197, v4, v173
v_lshlrev_b32 v3, 16, v103
v_and_b32 v4, 0xffff0000, v103
v_fmac_f32 v198, v3, v173
v_fmac_f32 v199, v4, v173
s_waitcnt vmcnt(5)
v_lshlrev_b32 v3, 16, v104
v_and_b32 v4, 0xffff0000, v104
v_fmac_f32 v176, v3, v158
v_fmac_f32 v177, v4, v158
v_lshlrev_b32 v3, 16, v105
v_and_b32 v4, 0xffff0000, v105
v_fmac_f32 v178, v3, v158
v_fmac_f32 v179, v4, v158
v_lshlrev_b32 v3, 16, v106
v_and_b32 v4, 0xffff0000, v106
v_fmac_f32 v180, v3, v158
v_fmac_f32 v181, v4, v158
v_lshlrev_b32 v3, 16, v107
v_and_b32 v4, 0xffff0000, v107
v_fmac_f32 v182, v3, v158
v_fmac_f32 v183, v4, v158
s_waitcnt vmcnt(4)
v_lshlrev_b32 v3, 16, v108
v_and_b32 v4, 0xffff0000, v108
v_fmac_f32 v184, v3, v166
v_fmac_f32 v185, v4, v166
v_lshlrev_b32 v3, 16, v109
v_and_b32 v4, 0xffff0000, v109
v_fmac_f32 v186, v3, v166
v_fmac_f32 v187, v4, v166
v_lshlrev_b32 v3, 16, v110
v_and_b32 v4, 0xffff0000, v110
v_fmac_f32 v188, v3, v166
v_fmac_f32 v189, v4, v166
v_lshlrev_b32 v3, 16, v111
v_and_b32 v4, 0xffff0000, v111
v_fmac_f32 v190, v3, v166
v_fmac_f32 v191, v4, v166
s_waitcnt vmcnt(3)
v_lshlrev_b32 v3, 16, v112
v_and_b32 v4, 0xffff0000, v112
v_fmac_f32 v192, v3, v174
v_fmac_f32 v193, v4, v174
v_lshlrev_b32 v3, 16, v113
v_and_b32 v4, 0xffff0000, v113
v_fmac_f32 v194, v3, v174
v_fmac_f32 v195, v4, v174
v_lshlrev_b32 v3, 16, v114
v_and_b32 v4, 0xffff0000, v114
v_fmac_f32 v196, v3, v174
v_fmac_f32 v197, v4, v174
v_lshlrev_b32 v3, 16, v115
v_and_b32 v4, 0xffff0000, v115
v_fmac_f32 v198, v3, v174
v_fmac_f32 v199, v4, v174
s_waitcnt vmcnt(2)
v_lshlrev_b32 v3, 16, v116
v_and_b32 v4, 0xffff0000, v116
v_fmac_f32 v176, v3, v159
v_fmac_f32 v177, v4, v159
v_lshlrev_b32 v3, 16, v117
v_and_b32 v4, 0xffff0000, v117
v_fmac_f32 v178, v3, v159
v_fmac_f32 v179, v4, v159
v_lshlrev_b32 v3, 16, v118
v_and_b32 v4, 0xffff0000, v118
v_fmac_f32 v180, v3, v159
v_fmac_f32 v181, v4, v159
v_lshlrev_b32 v3, 16, v119
v_and_b32 v4, 0xffff0000, v119
v_fmac_f32 v182, v3, v159
v_fmac_f32 v183, v4, v159
s_waitcnt vmcnt(1)
v_lshlrev_b32 v3, 16, v120
v_and_b32 v4, 0xffff0000, v120
v_fmac_f32 v184, v3, v167
v_fmac_f32 v185, v4, v167
v_lshlrev_b32 v3, 16, v121
v_and_b32 v4, 0xffff0000, v121
v_fmac_f32 v186, v3, v167
v_fmac_f32 v187, v4, v167
v_lshlrev_b32 v3, 16, v122
v_and_b32 v4, 0xffff0000, v122
v_fmac_f32 v188, v3, v167
v_fmac_f32 v189, v4, v167
v_lshlrev_b32 v3, 16, v123
v_and_b32 v4, 0xffff0000, v123
v_fmac_f32 v190, v3, v167
v_fmac_f32 v191, v4, v167
s_waitcnt vmcnt(0)
v_lshlrev_b32 v3, 16, v124
v_and_b32 v4, 0xffff0000, v124
v_fmac_f32 v192, v3, v175
v_fmac_f32 v193, v4, v175
v_lshlrev_b32 v3, 16, v125
v_and_b32 v4, 0xffff0000, v125
v_fmac_f32 v194, v3, v175
v_fmac_f32 v195, v4, v175
v_lshlrev_b32 v3, 16, v126
v_and_b32 v4, 0xffff0000, v126
v_fmac_f32 v196, v3, v175
v_fmac_f32 v197, v4, v175
v_lshlrev_b32 v3, 16, v127
v_and_b32 v4, 0xffff0000, v127
v_fmac_f32 v198, v3, v175
v_fmac_f32 v199, v4, v175
PV_D:
ds_write_b128 v5, v[176:179] offset:0
ds_write_b128 v5, v[180:183] offset:16
ds_write_b128 v5, v[184:187] offset:2304
ds_write_b128 v5, v[188:191] offset:2320
ds_write_b128 v5, v[192:195] offset:4608
ds_write_b128 v5, v[196:199] offset:4624
s_waitcnt vmcnt(0) lgkmcnt(0)
s_cmp_eq_u32 s24, 0
s_cbranch_scc1 GATE_D
s_cmp_ge_u32 s24, 4
s_cbranch_scc1 GATE_D
s_sub_u32 s33, s24, 1
s_lshl_b32 s33, s33, 8
s_add_u32 s33, s33, s2
s_cmp_ge_u32 s33, 640
s_cbranch_scc1 GATE_D
s_mov_b32 s80, s64
s_and_b32 s81, s65, 0xffff
s_mov_b32 s82, 0xc00
s_mov_b32 s83, 0x00020000
s_mov_b32 s84, s66
s_and_b32 s85, s67, 0xffff
s_mov_b32 s86, 0xc00
s_mov_b32 s87, 0x00020000
s_mov_b32 s88, s68
s_and_b32 s89, s69, 0xffff
s_mov_b32 s90, 0xc00
s_mov_b32 s91, 0x00020000
s_mov_b32 s92, s70
s_and_b32 s93, s71, 0xffff
s_mov_b32 s94, 0x2
s_mov_b32 s95, 0x00020000
v_lshlrev_b32 v8, 4, v1
buffer_load_dwordx4 v[140:143], v8, s[80:83], 0 offen offset:0
buffer_load_dwordx4 v[152:155], v8, s[84:87], 0 offen offset:0
buffer_load_dwordx4 v[164:167], v8, s[88:91], 0 offen offset:0
buffer_load_dwordx4 v[144:147], v8, s[80:83], 0 offen offset:1024
buffer_load_dwordx4 v[156:159], v8, s[84:87], 0 offen offset:1024
buffer_load_dwordx4 v[168:171], v8, s[88:91], 0 offen offset:1024
buffer_load_dwordx4 v[148:151], v8, s[80:83], 0 offen offset:2048
buffer_load_dwordx4 v[160:163], v8, s[84:87], 0 offen offset:2048
buffer_load_dwordx4 v[172:175], v8, s[88:91], 0 offen offset:2048
v_mov_b32 v9, 0
buffer_load_ushort v176, v9, s[92:95], 0 offen
v_mul_u32_u24 v6, 2560, v2
v_add_u32 v6, 59008, v6
v_lshl_add_u32 v7, v1, 3, v6
ds_read_b64 v[20:21], v7 offset:0
ds_read_b64 v[22:23], v7 offset:512
ds_read_b64 v[24:25], v7 offset:1024
ds_read_b64 v[26:27], v7 offset:1536
ds_read_b64 v[28:29], v7 offset:2048
s_waitcnt lgkmcnt(0)
v_mov_b32 v30, v20
v_add_f32 v30, v30, v21
v_add_f32 v30, v30, v22
v_add_f32 v30, v30, v23
v_add_f32 v30, v30, v24
v_add_f32 v30, v30, v25
v_add_f32 v30, v30, v26
v_add_f32 v30, v30, v27
v_add_f32 v30, v30, v28
v_add_f32 v30, v30, v29
s_nop 1
v_add_f32_dpp v30, v30, v30 quad_perm:[1,0,3,2] row_mask:0xf bank_mask:0xf
s_nop 1
v_add_f32_dpp v30, v30, v30 quad_perm:[2,3,0,1] row_mask:0xf bank_mask:0xf
s_nop 1
v_add_f32_dpp v30, v30, v30 row_half_mirror row_mask:0xf bank_mask:0xf
s_nop 1
v_add_f32_dpp v30, v30, v30 row_mirror row_mask:0xf bank_mask:0xf
s_nop 1
v_add_f32_dpp v30, v30, v30 row_bcast:15 row_mask:0xa bank_mask:0xf
s_nop 1
v_add_f32_dpp v30, v30, v30 row_bcast:31 row_mask:0xc bank_mask:0xf
s_nop 1
v_readlane_b32 s40, v30, 63
s_nop 3
v_mov_b32 v30, s40
v_mul_f32 v30, 0x3acccccd, v30
v_mov_b32 v31, 0
v_sub_f32 v32, v20, v30
v_fmac_f32 v31, v32, v32
v_sub_f32 v32, v21, v30
v_fmac_f32 v31, v32, v32
v_sub_f32 v32, v22, v30
v_fmac_f32 v31, v32, v32
v_sub_f32 v32, v23, v30
v_fmac_f32 v31, v32, v32
v_sub_f32 v32, v24, v30
v_fmac_f32 v31, v32, v32
v_sub_f32 v32, v25, v30
v_fmac_f32 v31, v32, v32
v_sub_f32 v32, v26, v30
v_fmac_f32 v31, v32, v32
v_sub_f32 v32, v27, v30
v_fmac_f32 v31, v32, v32
v_sub_f32 v32, v28, v30
v_fmac_f32 v31, v32, v32
v_sub_f32 v32, v29, v30
v_fmac_f32 v31, v32, v32
s_nop 1
v_add_f32_dpp v31, v31, v31 quad_perm:[1,0,3,2] row_mask:0xf bank_mask:0xf
s_nop 1
v_add_f32_dpp v31, v31, v31 quad_perm:[2,3,0,1] row_mask:0xf bank_mask:0xf
s_nop 1
v_add_f32_dpp v31, v31, v31 row_half_mirror row_mask:0xf bank_mask:0xf
s_nop 1
v_add_f32_dpp v31, v31, v31 row_mirror row_mask:0xf bank_mask:0xf
s_nop 1
v_add_f32_dpp v31, v31, v31 row_bcast:15 row_mask:0xa bank_mask:0xf
s_nop 1
v_add_f32_dpp v31, v31, v31 row_bcast:31 row_mask:0xc bank_mask:0xf
s_nop 1
v_readlane_b32 s41, v31, 63
s_nop 3
v_mov_b32 v31, s41
v_mul_f32 v31, 0x3acccccd, v31
v_cvt_pk_bf16_f32 v32, v31, v31
v_lshlrev_b32 v31, 16, v32
v_add_f32 v31, 0x3727c5ac, v31
v_cvt_pk_bf16_f32 v32, v31, v31
v_lshlrev_b32 v31, 16, v32
v_sqrt_f32 v31, v31
s_nop 0
v_cvt_pk_bf16_f32 v32, v31, v31
v_lshlrev_b32 v31, 16, v32
v_rcp_f32 v31, v31
s_nop 0
v_cvt_pk_bf16_f32 v32, v30, v30
v_lshlrev_b32 v30, 16, v32
v_sub_f32 v20, v20, v30
v_cvt_pk_bf16_f32 v32, v20, v20
v_lshlrev_b32 v20, 16, v32
v_mul_f32 v20, v20, v31
v_cvt_pk_bf16_f32 v32, v20, v20
v_lshlrev_b32 v20, 16, v32
v_sub_f32 v21, v21, v30
v_cvt_pk_bf16_f32 v32, v21, v21
v_lshlrev_b32 v21, 16, v32
v_mul_f32 v21, v21, v31
v_cvt_pk_bf16_f32 v32, v21, v21
v_lshlrev_b32 v21, 16, v32
v_sub_f32 v22, v22, v30
v_cvt_pk_bf16_f32 v32, v22, v22
v_lshlrev_b32 v22, 16, v32
v_mul_f32 v22, v22, v31
v_cvt_pk_bf16_f32 v32, v22, v22
v_lshlrev_b32 v22, 16, v32
v_sub_f32 v23, v23, v30
v_cvt_pk_bf16_f32 v32, v23, v23
v_lshlrev_b32 v23, 16, v32
v_mul_f32 v23, v23, v31
v_cvt_pk_bf16_f32 v32, v23, v23
v_lshlrev_b32 v23, 16, v32
v_sub_f32 v24, v24, v30
v_cvt_pk_bf16_f32 v32, v24, v24
v_lshlrev_b32 v24, 16, v32
v_mul_f32 v24, v24, v31
v_cvt_pk_bf16_f32 v32, v24, v24
v_lshlrev_b32 v24, 16, v32
v_sub_f32 v25, v25, v30
v_cvt_pk_bf16_f32 v32, v25, v25
v_lshlrev_b32 v25, 16, v32
v_mul_f32 v25, v25, v31
v_cvt_pk_bf16_f32 v32, v25, v25
v_lshlrev_b32 v25, 16, v32
v_sub_f32 v26, v26, v30
v_cvt_pk_bf16_f32 v32, v26, v26
v_lshlrev_b32 v26, 16, v32
v_mul_f32 v26, v26, v31
v_cvt_pk_bf16_f32 v32, v26, v26
v_lshlrev_b32 v26, 16, v32
v_sub_f32 v27, v27, v30
v_cvt_pk_bf16_f32 v32, v27, v27
v_lshlrev_b32 v27, 16, v32
v_mul_f32 v27, v27, v31
v_cvt_pk_bf16_f32 v32, v27, v27
v_lshlrev_b32 v27, 16, v32
v_sub_f32 v28, v28, v30
v_cvt_pk_bf16_f32 v32, v28, v28
v_lshlrev_b32 v28, 16, v32
v_mul_f32 v28, v28, v31
v_cvt_pk_bf16_f32 v32, v28, v28
v_lshlrev_b32 v28, 16, v32
v_sub_f32 v29, v29, v30
v_cvt_pk_bf16_f32 v32, v29, v29
v_lshlrev_b32 v29, 16, v32
v_mul_f32 v29, v29, v31
v_cvt_pk_bf16_f32 v32, v29, v29
v_lshlrev_b32 v29, 16, v32
ds_write_b64 v7, v[20:21] offset:0
ds_write_b64 v7, v[22:23] offset:512
ds_write_b64 v7, v[24:25] offset:1024
ds_write_b64 v7, v[26:27] offset:1536
ds_write_b64 v7, v[28:29] offset:2048
v_mov_b32 v9, s33
v_lshl_add_u32 v10, v9, 2, v6
s_waitcnt lgkmcnt(0)
ds_read_b32 v11, v10
v_mov_b32 v12, 0
s_mov_b32 s34, 0x3d372713
s_mov_b32 s35, 0xc0135761
s_waitcnt vmcnt(0) lgkmcnt(0)
v_lshlrev_b32 v13, 16, v140
v_lshlrev_b32 v14, 16, v152
v_lshlrev_b32 v15, 16, v164
v_mul_f32 v13, v13, v11
v_cvt_pk_bf16_f32 v16, v13, v13
v_lshlrev_b32 v13, 16, v16
v_add_f32 v13, v13, v14
v_cvt_pk_bf16_f32 v16, v13, v13
v_lshlrev_b32 v13, 16, v16
v_mul_f32 v16, v13, v13
v_mul_f32 v16, s34, v16
v_fma_f32 v16, v16, v13, v13
v_mul_f32 v16, s35, v16
v_exp_f32 v16, v16
s_nop 0
v_add_f32 v16, 1.0, v16
v_rcp_f32 v16, v16
s_nop 0
v_mul_f32 v13, v13, v16
v_cvt_pk_bf16_f32 v16, v13, v13
v_lshlrev_b32 v13, 16, v16
v_fmac_f32 v12, v13, v15
v_and_b32 v13, 0xffff0000, v140
v_and_b32 v14, 0xffff0000, v152
v_and_b32 v15, 0xffff0000, v164
v_mul_f32 v13, v13, v11
v_cvt_pk_bf16_f32 v16, v13, v13
v_lshlrev_b32 v13, 16, v16
v_add_f32 v13, v13, v14
v_cvt_pk_bf16_f32 v16, v13, v13
v_lshlrev_b32 v13, 16, v16
v_mul_f32 v16, v13, v13
v_mul_f32 v16, s34, v16
v_fma_f32 v16, v16, v13, v13
v_mul_f32 v16, s35, v16
v_exp_f32 v16, v16
s_nop 0
v_add_f32 v16, 1.0, v16
v_rcp_f32 v16, v16
s_nop 0
v_mul_f32 v13, v13, v16
v_cvt_pk_bf16_f32 v16, v13, v13
v_lshlrev_b32 v13, 16, v16
v_fmac_f32 v12, v13, v15
v_lshlrev_b32 v13, 16, v141
v_lshlrev_b32 v14, 16, v153
v_lshlrev_b32 v15, 16, v165
v_mul_f32 v13, v13, v11
v_cvt_pk_bf16_f32 v16, v13, v13
v_lshlrev_b32 v13, 16, v16
v_add_f32 v13, v13, v14
v_cvt_pk_bf16_f32 v16, v13, v13
v_lshlrev_b32 v13, 16, v16
v_mul_f32 v16, v13, v13
v_mul_f32 v16, s34, v16
v_fma_f32 v16, v16, v13, v13
v_mul_f32 v16, s35, v16
v_exp_f32 v16, v16
s_nop 0
v_add_f32 v16, 1.0, v16
v_rcp_f32 v16, v16
s_nop 0
v_mul_f32 v13, v13, v16
v_cvt_pk_bf16_f32 v16, v13, v13
v_lshlrev_b32 v13, 16, v16
v_fmac_f32 v12, v13, v15
v_and_b32 v13, 0xffff0000, v141
v_and_b32 v14, 0xffff0000, v153
v_and_b32 v15, 0xffff0000, v165
v_mul_f32 v13, v13, v11
v_cvt_pk_bf16_f32 v16, v13, v13
v_lshlrev_b32 v13, 16, v16
v_add_f32 v13, v13, v14
v_cvt_pk_bf16_f32 v16, v13, v13
v_lshlrev_b32 v13, 16, v16
v_mul_f32 v16, v13, v13
v_mul_f32 v16, s34, v16
v_fma_f32 v16, v16, v13, v13
v_mul_f32 v16, s35, v16
v_exp_f32 v16, v16
s_nop 0
v_add_f32 v16, 1.0, v16
v_rcp_f32 v16, v16
s_nop 0
v_mul_f32 v13, v13, v16
v_cvt_pk_bf16_f32 v16, v13, v13
v_lshlrev_b32 v13, 16, v16
v_fmac_f32 v12, v13, v15
v_lshlrev_b32 v13, 16, v142
v_lshlrev_b32 v14, 16, v154
v_lshlrev_b32 v15, 16, v166
v_mul_f32 v13, v13, v11
v_cvt_pk_bf16_f32 v16, v13, v13
v_lshlrev_b32 v13, 16, v16
v_add_f32 v13, v13, v14
v_cvt_pk_bf16_f32 v16, v13, v13
v_lshlrev_b32 v13, 16, v16
v_mul_f32 v16, v13, v13
v_mul_f32 v16, s34, v16
v_fma_f32 v16, v16, v13, v13
v_mul_f32 v16, s35, v16
v_exp_f32 v16, v16
s_nop 0
v_add_f32 v16, 1.0, v16
v_rcp_f32 v16, v16
s_nop 0
v_mul_f32 v13, v13, v16
v_cvt_pk_bf16_f32 v16, v13, v13
v_lshlrev_b32 v13, 16, v16
v_fmac_f32 v12, v13, v15
v_and_b32 v13, 0xffff0000, v142
v_and_b32 v14, 0xffff0000, v154
v_and_b32 v15, 0xffff0000, v166
v_mul_f32 v13, v13, v11
v_cvt_pk_bf16_f32 v16, v13, v13
v_lshlrev_b32 v13, 16, v16
v_add_f32 v13, v13, v14
v_cvt_pk_bf16_f32 v16, v13, v13
v_lshlrev_b32 v13, 16, v16
v_mul_f32 v16, v13, v13
v_mul_f32 v16, s34, v16
v_fma_f32 v16, v16, v13, v13
v_mul_f32 v16, s35, v16
v_exp_f32 v16, v16
s_nop 0
v_add_f32 v16, 1.0, v16
v_rcp_f32 v16, v16
s_nop 0
v_mul_f32 v13, v13, v16
v_cvt_pk_bf16_f32 v16, v13, v13
v_lshlrev_b32 v13, 16, v16
v_fmac_f32 v12, v13, v15
v_lshlrev_b32 v13, 16, v143
v_lshlrev_b32 v14, 16, v155
v_lshlrev_b32 v15, 16, v167
v_mul_f32 v13, v13, v11
v_cvt_pk_bf16_f32 v16, v13, v13
v_lshlrev_b32 v13, 16, v16
v_add_f32 v13, v13, v14
v_cvt_pk_bf16_f32 v16, v13, v13
v_lshlrev_b32 v13, 16, v16
v_mul_f32 v16, v13, v13
v_mul_f32 v16, s34, v16
v_fma_f32 v16, v16, v13, v13
v_mul_f32 v16, s35, v16
v_exp_f32 v16, v16
s_nop 0
v_add_f32 v16, 1.0, v16
v_rcp_f32 v16, v16
s_nop 0
v_mul_f32 v13, v13, v16
v_cvt_pk_bf16_f32 v16, v13, v13
v_lshlrev_b32 v13, 16, v16
v_fmac_f32 v12, v13, v15
v_and_b32 v13, 0xffff0000, v143
v_and_b32 v14, 0xffff0000, v155
v_and_b32 v15, 0xffff0000, v167
v_mul_f32 v13, v13, v11
v_cvt_pk_bf16_f32 v16, v13, v13
v_lshlrev_b32 v13, 16, v16
v_add_f32 v13, v13, v14
v_cvt_pk_bf16_f32 v16, v13, v13
v_lshlrev_b32 v13, 16, v16
v_mul_f32 v16, v13, v13
v_mul_f32 v16, s34, v16
v_fma_f32 v16, v16, v13, v13
v_mul_f32 v16, s35, v16
v_exp_f32 v16, v16
s_nop 0
v_add_f32 v16, 1.0, v16
v_rcp_f32 v16, v16
s_nop 0
v_mul_f32 v13, v13, v16
v_cvt_pk_bf16_f32 v16, v13, v13
v_lshlrev_b32 v13, 16, v16
v_fmac_f32 v12, v13, v15
v_lshlrev_b32 v13, 16, v144
v_lshlrev_b32 v14, 16, v156
v_lshlrev_b32 v15, 16, v168
v_mul_f32 v13, v13, v11
v_cvt_pk_bf16_f32 v16, v13, v13
v_lshlrev_b32 v13, 16, v16
v_add_f32 v13, v13, v14
v_cvt_pk_bf16_f32 v16, v13, v13
v_lshlrev_b32 v13, 16, v16
v_mul_f32 v16, v13, v13
v_mul_f32 v16, s34, v16
v_fma_f32 v16, v16, v13, v13
v_mul_f32 v16, s35, v16
v_exp_f32 v16, v16
s_nop 0
v_add_f32 v16, 1.0, v16
v_rcp_f32 v16, v16
s_nop 0
v_mul_f32 v13, v13, v16
v_cvt_pk_bf16_f32 v16, v13, v13
v_lshlrev_b32 v13, 16, v16
v_fmac_f32 v12, v13, v15
v_and_b32 v13, 0xffff0000, v144
v_and_b32 v14, 0xffff0000, v156
v_and_b32 v15, 0xffff0000, v168
v_mul_f32 v13, v13, v11
v_cvt_pk_bf16_f32 v16, v13, v13
v_lshlrev_b32 v13, 16, v16
v_add_f32 v13, v13, v14
v_cvt_pk_bf16_f32 v16, v13, v13
v_lshlrev_b32 v13, 16, v16
v_mul_f32 v16, v13, v13
v_mul_f32 v16, s34, v16
v_fma_f32 v16, v16, v13, v13
v_mul_f32 v16, s35, v16
v_exp_f32 v16, v16
s_nop 0
v_add_f32 v16, 1.0, v16
v_rcp_f32 v16, v16
s_nop 0
v_mul_f32 v13, v13, v16
v_cvt_pk_bf16_f32 v16, v13, v13
v_lshlrev_b32 v13, 16, v16
v_fmac_f32 v12, v13, v15
v_lshlrev_b32 v13, 16, v145
v_lshlrev_b32 v14, 16, v157
v_lshlrev_b32 v15, 16, v169
v_mul_f32 v13, v13, v11
v_cvt_pk_bf16_f32 v16, v13, v13
v_lshlrev_b32 v13, 16, v16
v_add_f32 v13, v13, v14
v_cvt_pk_bf16_f32 v16, v13, v13
v_lshlrev_b32 v13, 16, v16
v_mul_f32 v16, v13, v13
v_mul_f32 v16, s34, v16
v_fma_f32 v16, v16, v13, v13
v_mul_f32 v16, s35, v16
v_exp_f32 v16, v16
s_nop 0
v_add_f32 v16, 1.0, v16
v_rcp_f32 v16, v16
s_nop 0
v_mul_f32 v13, v13, v16
v_cvt_pk_bf16_f32 v16, v13, v13
v_lshlrev_b32 v13, 16, v16
v_fmac_f32 v12, v13, v15
v_and_b32 v13, 0xffff0000, v145
v_and_b32 v14, 0xffff0000, v157
v_and_b32 v15, 0xffff0000, v169
v_mul_f32 v13, v13, v11
v_cvt_pk_bf16_f32 v16, v13, v13
v_lshlrev_b32 v13, 16, v16
v_add_f32 v13, v13, v14
v_cvt_pk_bf16_f32 v16, v13, v13
v_lshlrev_b32 v13, 16, v16
v_mul_f32 v16, v13, v13
v_mul_f32 v16, s34, v16
v_fma_f32 v16, v16, v13, v13
v_mul_f32 v16, s35, v16
v_exp_f32 v16, v16
s_nop 0
v_add_f32 v16, 1.0, v16
v_rcp_f32 v16, v16
s_nop 0
v_mul_f32 v13, v13, v16
v_cvt_pk_bf16_f32 v16, v13, v13
v_lshlrev_b32 v13, 16, v16
v_fmac_f32 v12, v13, v15
v_lshlrev_b32 v13, 16, v146
v_lshlrev_b32 v14, 16, v158
v_lshlrev_b32 v15, 16, v170
v_mul_f32 v13, v13, v11
v_cvt_pk_bf16_f32 v16, v13, v13
v_lshlrev_b32 v13, 16, v16
v_add_f32 v13, v13, v14
v_cvt_pk_bf16_f32 v16, v13, v13
v_lshlrev_b32 v13, 16, v16
v_mul_f32 v16, v13, v13
v_mul_f32 v16, s34, v16
v_fma_f32 v16, v16, v13, v13
v_mul_f32 v16, s35, v16
v_exp_f32 v16, v16
s_nop 0
v_add_f32 v16, 1.0, v16
v_rcp_f32 v16, v16
s_nop 0
v_mul_f32 v13, v13, v16
v_cvt_pk_bf16_f32 v16, v13, v13
v_lshlrev_b32 v13, 16, v16
v_fmac_f32 v12, v13, v15
v_and_b32 v13, 0xffff0000, v146
v_and_b32 v14, 0xffff0000, v158
v_and_b32 v15, 0xffff0000, v170
v_mul_f32 v13, v13, v11
v_cvt_pk_bf16_f32 v16, v13, v13
v_lshlrev_b32 v13, 16, v16
v_add_f32 v13, v13, v14
v_cvt_pk_bf16_f32 v16, v13, v13
v_lshlrev_b32 v13, 16, v16
v_mul_f32 v16, v13, v13
v_mul_f32 v16, s34, v16
v_fma_f32 v16, v16, v13, v13
v_mul_f32 v16, s35, v16
v_exp_f32 v16, v16
s_nop 0
v_add_f32 v16, 1.0, v16
v_rcp_f32 v16, v16
s_nop 0
v_mul_f32 v13, v13, v16
v_cvt_pk_bf16_f32 v16, v13, v13
v_lshlrev_b32 v13, 16, v16
v_fmac_f32 v12, v13, v15
v_lshlrev_b32 v13, 16, v147
v_lshlrev_b32 v14, 16, v159
v_lshlrev_b32 v15, 16, v171
v_mul_f32 v13, v13, v11
v_cvt_pk_bf16_f32 v16, v13, v13
v_lshlrev_b32 v13, 16, v16
v_add_f32 v13, v13, v14
v_cvt_pk_bf16_f32 v16, v13, v13
v_lshlrev_b32 v13, 16, v16
v_mul_f32 v16, v13, v13
v_mul_f32 v16, s34, v16
v_fma_f32 v16, v16, v13, v13
v_mul_f32 v16, s35, v16
v_exp_f32 v16, v16
s_nop 0
v_add_f32 v16, 1.0, v16
v_rcp_f32 v16, v16
s_nop 0
v_mul_f32 v13, v13, v16
v_cvt_pk_bf16_f32 v16, v13, v13
v_lshlrev_b32 v13, 16, v16
v_fmac_f32 v12, v13, v15
v_and_b32 v13, 0xffff0000, v147
v_and_b32 v14, 0xffff0000, v159
v_and_b32 v15, 0xffff0000, v171
v_mul_f32 v13, v13, v11
v_cvt_pk_bf16_f32 v16, v13, v13
v_lshlrev_b32 v13, 16, v16
v_add_f32 v13, v13, v14
v_cvt_pk_bf16_f32 v16, v13, v13
v_lshlrev_b32 v13, 16, v16
v_mul_f32 v16, v13, v13
v_mul_f32 v16, s34, v16
v_fma_f32 v16, v16, v13, v13
v_mul_f32 v16, s35, v16
v_exp_f32 v16, v16
s_nop 0
v_add_f32 v16, 1.0, v16
v_rcp_f32 v16, v16
s_nop 0
v_mul_f32 v13, v13, v16
v_cvt_pk_bf16_f32 v16, v13, v13
v_lshlrev_b32 v13, 16, v16
v_fmac_f32 v12, v13, v15
v_lshlrev_b32 v13, 16, v148
v_lshlrev_b32 v14, 16, v160
v_lshlrev_b32 v15, 16, v172
v_mul_f32 v13, v13, v11
v_cvt_pk_bf16_f32 v16, v13, v13
v_lshlrev_b32 v13, 16, v16
v_add_f32 v13, v13, v14
v_cvt_pk_bf16_f32 v16, v13, v13
v_lshlrev_b32 v13, 16, v16
v_mul_f32 v16, v13, v13
v_mul_f32 v16, s34, v16
v_fma_f32 v16, v16, v13, v13
v_mul_f32 v16, s35, v16
v_exp_f32 v16, v16
s_nop 0
v_add_f32 v16, 1.0, v16
v_rcp_f32 v16, v16
s_nop 0
v_mul_f32 v13, v13, v16
v_cvt_pk_bf16_f32 v16, v13, v13
v_lshlrev_b32 v13, 16, v16
v_fmac_f32 v12, v13, v15
v_and_b32 v13, 0xffff0000, v148
v_and_b32 v14, 0xffff0000, v160
v_and_b32 v15, 0xffff0000, v172
v_mul_f32 v13, v13, v11
v_cvt_pk_bf16_f32 v16, v13, v13
v_lshlrev_b32 v13, 16, v16
v_add_f32 v13, v13, v14
v_cvt_pk_bf16_f32 v16, v13, v13
v_lshlrev_b32 v13, 16, v16
v_mul_f32 v16, v13, v13
v_mul_f32 v16, s34, v16
v_fma_f32 v16, v16, v13, v13
v_mul_f32 v16, s35, v16
v_exp_f32 v16, v16
s_nop 0
v_add_f32 v16, 1.0, v16
v_rcp_f32 v16, v16
s_nop 0
v_mul_f32 v13, v13, v16
v_cvt_pk_bf16_f32 v16, v13, v13
v_lshlrev_b32 v13, 16, v16
v_fmac_f32 v12, v13, v15
v_lshlrev_b32 v13, 16, v149
v_lshlrev_b32 v14, 16, v161
v_lshlrev_b32 v15, 16, v173
v_mul_f32 v13, v13, v11
v_cvt_pk_bf16_f32 v16, v13, v13
v_lshlrev_b32 v13, 16, v16
v_add_f32 v13, v13, v14
v_cvt_pk_bf16_f32 v16, v13, v13
v_lshlrev_b32 v13, 16, v16
v_mul_f32 v16, v13, v13
v_mul_f32 v16, s34, v16
v_fma_f32 v16, v16, v13, v13
v_mul_f32 v16, s35, v16
v_exp_f32 v16, v16
s_nop 0
v_add_f32 v16, 1.0, v16
v_rcp_f32 v16, v16
s_nop 0
v_mul_f32 v13, v13, v16
v_cvt_pk_bf16_f32 v16, v13, v13
v_lshlrev_b32 v13, 16, v16
v_fmac_f32 v12, v13, v15
v_and_b32 v13, 0xffff0000, v149
v_and_b32 v14, 0xffff0000, v161
v_and_b32 v15, 0xffff0000, v173
v_mul_f32 v13, v13, v11
v_cvt_pk_bf16_f32 v16, v13, v13
v_lshlrev_b32 v13, 16, v16
v_add_f32 v13, v13, v14
v_cvt_pk_bf16_f32 v16, v13, v13
v_lshlrev_b32 v13, 16, v16
v_mul_f32 v16, v13, v13
v_mul_f32 v16, s34, v16
v_fma_f32 v16, v16, v13, v13
v_mul_f32 v16, s35, v16
v_exp_f32 v16, v16
s_nop 0
v_add_f32 v16, 1.0, v16
v_rcp_f32 v16, v16
s_nop 0
v_mul_f32 v13, v13, v16
v_cvt_pk_bf16_f32 v16, v13, v13
v_lshlrev_b32 v13, 16, v16
v_fmac_f32 v12, v13, v15
v_lshlrev_b32 v13, 16, v150
v_lshlrev_b32 v14, 16, v162
v_lshlrev_b32 v15, 16, v174
v_mul_f32 v13, v13, v11
v_cvt_pk_bf16_f32 v16, v13, v13
v_lshlrev_b32 v13, 16, v16
v_add_f32 v13, v13, v14
v_cvt_pk_bf16_f32 v16, v13, v13
v_lshlrev_b32 v13, 16, v16
v_mul_f32 v16, v13, v13
v_mul_f32 v16, s34, v16
v_fma_f32 v16, v16, v13, v13
v_mul_f32 v16, s35, v16
v_exp_f32 v16, v16
s_nop 0
v_add_f32 v16, 1.0, v16
v_rcp_f32 v16, v16
s_nop 0
v_mul_f32 v13, v13, v16
v_cvt_pk_bf16_f32 v16, v13, v13
v_lshlrev_b32 v13, 16, v16
v_fmac_f32 v12, v13, v15
v_and_b32 v13, 0xffff0000, v150
v_and_b32 v14, 0xffff0000, v162
v_and_b32 v15, 0xffff0000, v174
v_mul_f32 v13, v13, v11
v_cvt_pk_bf16_f32 v16, v13, v13
v_lshlrev_b32 v13, 16, v16
v_add_f32 v13, v13, v14
v_cvt_pk_bf16_f32 v16, v13, v13
v_lshlrev_b32 v13, 16, v16
v_mul_f32 v16, v13, v13
v_mul_f32 v16, s34, v16
v_fma_f32 v16, v16, v13, v13
v_mul_f32 v16, s35, v16
v_exp_f32 v16, v16
s_nop 0
v_add_f32 v16, 1.0, v16
v_rcp_f32 v16, v16
s_nop 0
v_mul_f32 v13, v13, v16
v_cvt_pk_bf16_f32 v16, v13, v13
v_lshlrev_b32 v13, 16, v16
v_fmac_f32 v12, v13, v15
v_lshlrev_b32 v13, 16, v151
v_lshlrev_b32 v14, 16, v163
v_lshlrev_b32 v15, 16, v175
v_mul_f32 v13, v13, v11
v_cvt_pk_bf16_f32 v16, v13, v13
v_lshlrev_b32 v13, 16, v16
v_add_f32 v13, v13, v14
v_cvt_pk_bf16_f32 v16, v13, v13
v_lshlrev_b32 v13, 16, v16
v_mul_f32 v16, v13, v13
v_mul_f32 v16, s34, v16
v_fma_f32 v16, v16, v13, v13
v_mul_f32 v16, s35, v16
v_exp_f32 v16, v16
s_nop 0
v_add_f32 v16, 1.0, v16
v_rcp_f32 v16, v16
s_nop 0
v_mul_f32 v13, v13, v16
v_cvt_pk_bf16_f32 v16, v13, v13
v_lshlrev_b32 v13, 16, v16
v_fmac_f32 v12, v13, v15
v_and_b32 v13, 0xffff0000, v151
v_and_b32 v14, 0xffff0000, v163
v_and_b32 v15, 0xffff0000, v175
v_mul_f32 v13, v13, v11
v_cvt_pk_bf16_f32 v16, v13, v13
v_lshlrev_b32 v13, 16, v16
v_add_f32 v13, v13, v14
v_cvt_pk_bf16_f32 v16, v13, v13
v_lshlrev_b32 v13, 16, v16
v_mul_f32 v16, v13, v13
v_mul_f32 v16, s34, v16
v_fma_f32 v16, v16, v13, v13
v_mul_f32 v16, s35, v16
v_exp_f32 v16, v16
s_nop 0
v_add_f32 v16, 1.0, v16
v_rcp_f32 v16, v16
s_nop 0
v_mul_f32 v13, v13, v16
v_cvt_pk_bf16_f32 v16, v13, v13
v_lshlrev_b32 v13, 16, v16
v_fmac_f32 v12, v13, v15
s_nop 1
v_add_f32_dpp v12, v12, v12 quad_perm:[1,0,3,2] row_mask:0xf bank_mask:0xf
s_nop 1
v_add_f32_dpp v12, v12, v12 quad_perm:[2,3,0,1] row_mask:0xf bank_mask:0xf
s_nop 1
v_add_f32_dpp v12, v12, v12 row_half_mirror row_mask:0xf bank_mask:0xf
s_nop 1
v_add_f32_dpp v12, v12, v12 row_mirror row_mask:0xf bank_mask:0xf
s_nop 1
v_add_f32_dpp v12, v12, v12 row_bcast:15 row_mask:0xa bank_mask:0xf
s_nop 1
v_add_f32_dpp v12, v12, v12 row_bcast:31 row_mask:0xc bank_mask:0xf
s_nop 1
v_readlane_b32 s37, v12, 63
s_nop 3
v_mov_b32 v12, s37
v_cvt_pk_bf16_f32 v16, v12, v12
v_lshlrev_b32 v12, 16, v16
v_lshlrev_b32 v176, 16, v176
v_add_f32 v12, v12, v176
v_cvt_pk_bf16_f32 v16, v12, v12
v_lshlrev_b32 v12, 16, v16
v_mul_f32 v13, 0xbfb8aa3b, v12
v_exp_f32 v13, v13
s_nop 0
v_add_f32 v13, 1.0, v13
v_rcp_f32 v13, v13
s_nop 0
v_mul_f32 v12, v12, v13
v_cvt_pk_bf16_f32 v16, v12, v12
v_lshlrev_b32 v12, 16, v16
v_mov_b32 v13, s38
v_lshlrev_b32 v9, 3, v9
s_mov_b32 s27, 262144
v_cmp_eq_u32 vcc, 0, v1
s_and_saveexec_b64 s[40:41], vcc
buffer_store_dwordx2 v[12:13], v9, s[20:23], s27 offen sc1
s_mov_b64 exec, s[40:41]
GATE_D:
v_lshrrev_b32 v4, 3, v0
v_and_b32 v7, 7, v0
v_add_u32 v17, 0, v4
v_subrev_u32 v3, 24, v17
v_cmp_le_u32 vcc, 24, v17
s_nop 1
v_cndmask_b32 v17, v17, v3, vcc
v_lshlrev_b32 v17, 5, v17
v_lshl_add_u32 v10, v7, 2, v17
v_add_u32 v17, 8, v4
v_subrev_u32 v3, 24, v17
v_cmp_le_u32 vcc, 24, v17
s_nop 1
v_cndmask_b32 v17, v17, v3, vcc
v_lshlrev_b32 v17, 5, v17
v_lshl_add_u32 v11, v7, 2, v17
v_add_u32 v17, 16, v4
v_subrev_u32 v3, 24, v17
v_cmp_le_u32 vcc, 24, v17
s_nop 1
v_cndmask_b32 v17, v17, v3, vcc
v_lshlrev_b32 v17, 5, v17
v_lshl_add_u32 v12, v7, 2, v17
s_waitcnt vmcnt(0) lgkmcnt(0)
s_barrier
s_cmp_ge_u32 s24, 3
s_cbranch_scc1 HOP1_D
v_mov_b32 v4, 0
ds_read_b128 v[32:35], v4 offset:55808
ds_read_b128 v[36:39], v4 offset:55824
ds_read_b128 v[40:43], v4 offset:55840
ds_read_b128 v[44:47], v4 offset:55856
s_waitcnt lgkmcnt(0)
v_max3_f32 v3, v32, v34, v36
v_max3_f32 v3, v3, v38, v40
v_max3_f32 v3, v3, v42, v44
v_max_f32 v3, v3, v46
v_mov_b32 v7, 0
v_sub_f32 v48, v32, v3
v_mul_f32 v48, s36, v48
v_exp_f32 v48, v48
s_nop 0
v_fmac_f32 v7, v48, v33
v_sub_f32 v49, v34, v3
v_mul_f32 v49, s36, v49
v_exp_f32 v49, v49
s_nop 0
v_fmac_f32 v7, v49, v35
v_sub_f32 v50, v36, v3
v_mul_f32 v50, s36, v50
v_exp_f32 v50, v50
s_nop 0
v_fmac_f32 v7, v50, v37
v_sub_f32 v51, v38, v3
v_mul_f32 v51, s36, v51
v_exp_f32 v51, v51
s_nop 0
v_fmac_f32 v7, v51, v39
v_sub_f32 v52, v40, v3
v_mul_f32 v52, s36, v52
v_exp_f32 v52, v52
s_nop 0
v_fmac_f32 v7, v52, v41
v_sub_f32 v53, v42, v3
v_mul_f32 v53, s36, v53
v_exp_f32 v53, v53
s_nop 0
v_fmac_f32 v7, v53, v43
v_sub_f32 v54, v44, v3
v_mul_f32 v54, s36, v54
v_exp_f32 v54, v54
s_nop 0
v_fmac_f32 v7, v54, v45
v_sub_f32 v55, v46, v3
v_mul_f32 v55, s36, v55
v_exp_f32 v55, v55
s_nop 0
v_fmac_f32 v7, v55, v47
v_mov_b32 v80, 0
ds_read_b32 v60, v10 offset:0
ds_read_b32 v61, v10 offset:768
ds_read_b32 v62, v10 offset:1536
ds_read_b32 v63, v11 offset:2304
ds_read_b32 v64, v11 offset:3072
ds_read_b32 v65, v11 offset:3840
ds_read_b32 v66, v12 offset:4608
ds_read_b32 v67, v12 offset:5376
ds_read_b32 v68, v12 offset:6144
ds_read_b32 v69, v10 offset:6912
ds_read_b32 v70, v10 offset:7680
ds_read_b32 v71, v10 offset:8448
ds_read_b32 v72, v11 offset:9216
ds_read_b32 v73, v11 offset:9984
ds_read_b32 v74, v11 offset:10752
ds_read_b32 v75, v12 offset:11520
ds_read_b32 v76, v12 offset:12288
ds_read_b32 v77, v12 offset:13056
s_waitcnt lgkmcnt(9)
v_add_f32 v60, v60, v61
v_add_f32 v60, v60, v62
v_add_f32 v60, v60, v63
v_add_f32 v60, v60, v64
v_add_f32 v60, v60, v65
v_add_f32 v60, v60, v66
v_add_f32 v60, v60, v67
v_add_f32 v60, v60, v68
v_fmac_f32 v80, v48, v60
ds_read_b32 v60, v10 offset:13824
ds_read_b32 v61, v10 offset:14592
ds_read_b32 v62, v10 offset:15360
ds_read_b32 v63, v11 offset:16128
ds_read_b32 v64, v11 offset:16896
ds_read_b32 v65, v11 offset:17664
ds_read_b32 v66, v12 offset:18432
ds_read_b32 v67, v12 offset:19200
ds_read_b32 v68, v12 offset:19968
s_waitcnt lgkmcnt(9)
v_add_f32 v69, v69, v70
v_add_f32 v69, v69, v71
v_add_f32 v69, v69, v72
v_add_f32 v69, v69, v73
v_add_f32 v69, v69, v74
v_add_f32 v69, v69, v75
v_add_f32 v69, v69, v76
v_add_f32 v69, v69, v77
v_fmac_f32 v80, v49, v69
ds_read_b32 v69, v10 offset:20736
ds_read_b32 v70, v10 offset:21504
ds_read_b32 v71, v10 offset:22272
ds_read_b32 v72, v11 offset:23040
ds_read_b32 v73, v11 offset:23808
ds_read_b32 v74, v11 offset:24576
ds_read_b32 v75, v12 offset:25344
ds_read_b32 v76, v12 offset:26112
ds_read_b32 v77, v12 offset:26880
s_waitcnt lgkmcnt(9)
v_add_f32 v60, v60, v61
v_add_f32 v60, v60, v62
v_add_f32 v60, v60, v63
v_add_f32 v60, v60, v64
v_add_f32 v60, v60, v65
v_add_f32 v60, v60, v66
v_add_f32 v60, v60, v67
v_add_f32 v60, v60, v68
v_fmac_f32 v80, v50, v60
ds_read_b32 v60, v10 offset:27648
ds_read_b32 v61, v10 offset:28416
ds_read_b32 v62, v10 offset:29184
ds_read_b32 v63, v11 offset:29952
ds_read_b32 v64, v11 offset:30720
ds_read_b32 v65, v11 offset:31488
ds_read_b32 v66, v12 offset:32256
ds_read_b32 v67, v12 offset:33024
ds_read_b32 v68, v12 offset:33792
s_waitcnt lgkmcnt(9)
v_add_f32 v69, v69, v70
v_add_f32 v69, v69, v71
v_add_f32 v69, v69, v72
v_add_f32 v69, v69, v73
v_add_f32 v69, v69, v74
v_add_f32 v69, v69, v75
v_add_f32 v69, v69, v76
v_add_f32 v69, v69, v77
v_fmac_f32 v80, v51, v69
ds_read_b32 v69, v10 offset:34560
ds_read_b32 v70, v10 offset:35328
ds_read_b32 v71, v10 offset:36096
ds_read_b32 v72, v11 offset:36864
ds_read_b32 v73, v11 offset:37632
ds_read_b32 v74, v11 offset:38400
ds_read_b32 v75, v12 offset:39168
ds_read_b32 v76, v12 offset:39936
ds_read_b32 v77, v12 offset:40704
s_waitcnt lgkmcnt(9)
v_add_f32 v60, v60, v61
v_add_f32 v60, v60, v62
v_add_f32 v60, v60, v63
v_add_f32 v60, v60, v64
v_add_f32 v60, v60, v65
v_add_f32 v60, v60, v66
v_add_f32 v60, v60, v67
v_add_f32 v60, v60, v68
v_fmac_f32 v80, v52, v60
ds_read_b32 v60, v10 offset:41472
ds_read_b32 v61, v10 offset:42240
ds_read_b32 v62, v10 offset:43008
ds_read_b32 v63, v11 offset:43776
ds_read_b32 v64, v11 offset:44544
ds_read_b32 v65, v11 offset:45312
ds_read_b32 v66, v12 offset:46080
ds_read_b32 v67, v12 offset:46848
ds_read_b32 v68, v12 offset:47616
s_waitcnt lgkmcnt(9)
v_add_f32 v69, v69, v70
v_add_f32 v69, v69, v71
v_add_f32 v69, v69, v72
v_add_f32 v69, v69, v73
v_add_f32 v69, v69, v74
v_add_f32 v69, v69, v75
v_add_f32 v69, v69, v76
v_add_f32 v69, v69, v77
v_fmac_f32 v80, v53, v69
ds_read_b32 v69, v10 offset:48384
ds_read_b32 v70, v10 offset:49152
ds_read_b32 v71, v10 offset:49920
ds_read_b32 v72, v11 offset:50688
ds_read_b32 v73, v11 offset:51456
ds_read_b32 v74, v11 offset:52224
ds_read_b32 v75, v12 offset:52992
ds_read_b32 v76, v12 offset:53760
ds_read_b32 v77, v12 offset:54528
s_waitcnt lgkmcnt(9)
v_add_f32 v60, v60, v61
v_add_f32 v60, v60, v62
v_add_f32 v60, v60, v63
v_add_f32 v60, v60, v64
v_add_f32 v60, v60, v65
v_add_f32 v60, v60, v66
v_add_f32 v60, v60, v67
v_add_f32 v60, v60, v68
v_fmac_f32 v80, v54, v60
s_waitcnt lgkmcnt(0)
v_add_f32 v69, v69, v70
v_add_f32 v69, v69, v71
v_add_f32 v69, v69, v72
v_add_f32 v69, v69, v73
v_add_f32 v69, v69, v74
v_add_f32 v69, v69, v75
v_add_f32 v69, v69, v76
v_add_f32 v69, v69, v77
v_fmac_f32 v80, v55, v69
v_mov_b32 v81, s38
s_lshl_b32 s27, s31, 11
s_add_u32 s27, s27, 524288
v_lshlrev_b32 v4, 3, v0
buffer_store_dwordx2 v[80:81], v4, s[20:23], s27 offen sc1
v_mov_b32 v84, v3
v_mov_b32 v85, v7
v_mov_b32 v86, s38
v_mov_b32 v87, s38
v_cmp_eq_u32 vcc, 0, v0
s_and_saveexec_b64 s[40:41], vcc
buffer_store_dwordx4 v[84:87], v4, s[20:23], s27 offen offset:1536 sc1
s_mov_b64 exec, s[40:41]
s_cmp_eq_u32 s24, 0
s_cbranch_scc0 HOP1_D
s_lshl_b32 s27, s25, 14
s_add_u32 s27, s27, 524288
s_mul_i32 s29, s26, 192
v_min_u32 v3, 23, v1
v_lshlrev_b32 v3, 3, v3
v_add_u32 v3, s29, v3
v_mov_b32 v4, 1536
s_add_u32 s32, s27, 4096
s_add_u32 s33, s27, 8192
s_add_u32 s34, s27, 12288
s_mov_b32 s60, 0
PO:
buffer_load_dwordx2 v[64:65], v3, s[20:23], s27 offen offset:0 sc1
buffer_load_dwordx4 v[80:83], v4, s[20:23], s27 offen offset:0 sc1
buffer_load_dwordx2 v[66:67], v3, s[20:23], s27 offen offset:2048 sc1
buffer_load_dwordx4 v[84:87], v4, s[20:23], s27 offen offset:2048 sc1
buffer_load_dwordx2 v[68:69], v3, s[20:23], s32 offen offset:0 sc1
buffer_load_dwordx4 v[88:91], v4, s[20:23], s32 offen offset:0 sc1
buffer_load_dwordx2 v[70:71], v3, s[20:23], s32 offen offset:2048 sc1
buffer_load_dwordx4 v[92:95], v4, s[20:23], s32 offen offset:2048 sc1
buffer_load_dwordx2 v[72:73], v3, s[20:23], s33 offen offset:0 sc1
buffer_load_dwordx4 v[96:99], v4, s[20:23], s33 offen offset:0 sc1
buffer_load_dwordx2 v[74:75], v3, s[20:23], s33 offen offset:2048 sc1
buffer_load_dwordx4 v[100:103], v4, s[20:23], s33 offen offset:2048 sc1
buffer_load_dwordx2 v[76:77], v3, s[20:23], s34 offen offset:0 sc1
buffer_load_dwordx4 v[104:107], v4, s[20:23], s34 offen offset:0 sc1
buffer_load_dwordx2 v[78:79], v3, s[20:23], s34 offen offset:2048 sc1
buffer_load_dwordx4 v[108:111], v4, s[20:23], s34 offen offset:2048 sc1
s_waitcnt vmcnt(0)
v_cmp_ne_u32 vcc, s38, v65
v_cmp_ne_u32 s[42:43], s38, v82
s_or_b64 vcc, vcc, s[42:43]
v_cmp_ne_u32 s[42:43], s38, v67
s_or_b64 vcc, vcc, s[42:43]
v_cmp_ne_u32 s[42:43], s38, v86
s_or_b64 vcc, vcc, s[42:43]
v_cmp_ne_u32 s[42:43], s38, v69
s_or_b64 vcc, vcc, s[42:43]
v_cmp_ne_u32 s[42:43], s38, v90
s_or_b64 vcc, vcc, s[42:43]
v_cmp_ne_u32 s[42:43], s38, v71
s_or_b64 vcc, vcc, s[42:43]
v_cmp_ne_u32 s[42:43], s38, v94
s_or_b64 vcc, vcc, s[42:43]
v_cmp_ne_u32 s[42:43], s38, v73
s_or_b64 vcc, vcc, s[42:43]
v_cmp_ne_u32 s[42:43], s38, v98
s_or_b64 vcc, vcc, s[42:43]
v_cmp_ne_u32 s[42:43], s38, v75
s_or_b64 vcc, vcc, s[42:43]
v_cmp_ne_u32 s[42:43], s38, v102
s_or_b64 vcc, vcc, s[42:43]
v_cmp_ne_u32 s[42:43], s38, v77
s_or_b64 vcc, vcc, s[42:43]
v_cmp_ne_u32 s[42:43], s38, v106
s_or_b64 vcc, vcc, s[42:43]
v_cmp_ne_u32 s[42:43], s38, v79
s_or_b64 vcc, vcc, s[42:43]
v_cmp_ne_u32 s[42:43], s38, v110
s_or_b64 vcc, vcc, s[42:43]
s_cbranch_vccz PO_D
s_sleep 1
s_add_u32 s60, s60, 1
s_cmp_lt_u32 s60, 65536
s_cbranch_scc1 PO
PO_D:
v_mov_b32 v3, v80
v_max_f32 v3, v3, v84
v_max_f32 v3, v3, v88
v_max_f32 v3, v3, v92
v_max_f32 v3, v3, v96
v_max_f32 v3, v3, v100
v_max_f32 v3, v3, v104
v_max_f32 v3, v3, v108
v_mov_b32 v8, 0
v_mov_b32 v9, 0
v_sub_f32 v10, v80, v3
v_mul_f32 v10, s36, v10
v_exp_f32 v10, v10
s_nop 0
v_fmac_f32 v8, v10, v64
v_fmac_f32 v9, v10, v81
v_sub_f32 v10, v84, v3
v_mul_f32 v10, s36, v10
v_exp_f32 v10, v10
s_nop 0
v_fmac_f32 v8, v10, v66
v_fmac_f32 v9, v10, v85
v_sub_f32 v10, v88, v3
v_mul_f32 v10, s36, v10
v_exp_f32 v10, v10
s_nop 0
v_fmac_f32 v8, v10, v68
v_fmac_f32 v9, v10, v89
v_sub_f32 v10, v92, v3
v_mul_f32 v10, s36, v10
v_exp_f32 v10, v10
s_nop 0
v_fmac_f32 v8, v10, v70
v_fmac_f32 v9, v10, v93
v_sub_f32 v10, v96, v3
v_mul_f32 v10, s36, v10
v_exp_f32 v10, v10
s_nop 0
v_fmac_f32 v8, v10, v72
v_fmac_f32 v9, v10, v97
v_sub_f32 v10, v100, v3
v_mul_f32 v10, s36, v10
v_exp_f32 v10, v10
s_nop 0
v_fmac_f32 v8, v10, v74
v_fmac_f32 v9, v10, v101
v_sub_f32 v10, v104, v3
v_mul_f32 v10, s36, v10
v_exp_f32 v10, v10
s_nop 0
v_fmac_f32 v8, v10, v76
v_fmac_f32 v9, v10, v105
v_sub_f32 v10, v108, v3
v_mul_f32 v10, s36, v10
v_exp_f32 v10, v10
s_nop 0
v_fmac_f32 v8, v10, v78
v_fmac_f32 v9, v10, v109
v_rcp_f32 v9, v9
s_nop 0
v_mul_f32 v8, v8, v9
v_cvt_pk_bf16_f32 v10, v8, v8
v_lshlrev_b32 v8, 16, v10
v_lshlrev_b32 v3, 2, v1
ds_write_b32 v3, v8 offset:57984
s_waitcnt lgkmcnt(0)
s_branch HOP1_D
HOP1_D:
s_barrier
v_mul_u32_u24 v3, 52429, v0
v_lshrrev_b32 v3, 22, v3
v_mul_u32_u24 v4, 80, v3
v_sub_u32 v4, v0, v4
v_cmp_gt_u32 vcc, 480, v0
s_and_saveexec_b64 s[40:41], vcc
s_cbranch_execz GEMV_D
v_mul_u32_u24 v5, 5120, v3
v_lshl_add_u32 v5, v4, 4, v5
v_add_u32 v5, 79488, v5
v_lshlrev_b32 v6, 4, v3
ds_read_b128 v[20:23], v6 offset:57984
ds_read_b128 v[32:35], v5 offset:0
ds_read_b128 v[36:39], v5 offset:1280
ds_read_b128 v[40:43], v5 offset:2560
ds_read_b128 v[44:47], v5 offset:3840
v_mov_b32 v48, 0
v_mov_b32 v49, 0
v_mov_b32 v50, 0
v_mov_b32 v51, 0
v_mov_b32 v52, 0
v_mov_b32 v53, 0
v_mov_b32 v54, 0
v_mov_b32 v55, 0
s_waitcnt lgkmcnt(0)
v_lshlrev_b32 v7, 16, v32
v_and_b32 v8, 0xffff0000, v32
v_fmac_f32 v48, v7, v20
v_fmac_f32 v49, v8, v20
v_lshlrev_b32 v7, 16, v33
v_and_b32 v8, 0xffff0000, v33
v_fmac_f32 v50, v7, v20
v_fmac_f32 v51, v8, v20
v_lshlrev_b32 v7, 16, v34
v_and_b32 v8, 0xffff0000, v34
v_fmac_f32 v52, v7, v20
v_fmac_f32 v53, v8, v20
v_lshlrev_b32 v7, 16, v35
v_and_b32 v8, 0xffff0000, v35
v_fmac_f32 v54, v7, v20
v_fmac_f32 v55, v8, v20
v_lshlrev_b32 v7, 16, v36
v_and_b32 v8, 0xffff0000, v36
v_fmac_f32 v48, v7, v21
v_fmac_f32 v49, v8, v21
v_lshlrev_b32 v7, 16, v37
v_and_b32 v8, 0xffff0000, v37
v_fmac_f32 v50, v7, v21
v_fmac_f32 v51, v8, v21
v_lshlrev_b32 v7, 16, v38
v_and_b32 v8, 0xffff0000, v38
v_fmac_f32 v52, v7, v21
v_fmac_f32 v53, v8, v21
v_lshlrev_b32 v7, 16, v39
v_and_b32 v8, 0xffff0000, v39
v_fmac_f32 v54, v7, v21
v_fmac_f32 v55, v8, v21
v_lshlrev_b32 v7, 16, v40
v_and_b32 v8, 0xffff0000, v40
v_fmac_f32 v48, v7, v22
v_fmac_f32 v49, v8, v22
v_lshlrev_b32 v7, 16, v41
v_and_b32 v8, 0xffff0000, v41
v_fmac_f32 v50, v7, v22
v_fmac_f32 v51, v8, v22
v_lshlrev_b32 v7, 16, v42
v_and_b32 v8, 0xffff0000, v42
v_fmac_f32 v52, v7, v22
v_fmac_f32 v53, v8, v22
v_lshlrev_b32 v7, 16, v43
v_and_b32 v8, 0xffff0000, v43
v_fmac_f32 v54, v7, v22
v_fmac_f32 v55, v8, v22
v_lshlrev_b32 v7, 16, v44
v_and_b32 v8, 0xffff0000, v44
v_fmac_f32 v48, v7, v23
v_fmac_f32 v49, v8, v23
v_lshlrev_b32 v7, 16, v45
v_and_b32 v8, 0xffff0000, v45
v_fmac_f32 v50, v7, v23
v_fmac_f32 v51, v8, v23
v_lshlrev_b32 v7, 16, v46
v_and_b32 v8, 0xffff0000, v46
v_fmac_f32 v52, v7, v23
v_fmac_f32 v53, v8, v23
v_lshlrev_b32 v7, 16, v47
v_and_b32 v8, 0xffff0000, v47
v_fmac_f32 v54, v7, v23
v_fmac_f32 v55, v8, v23
v_mul_u32_u24 v5, 2560, v3
v_lshl_add_u32 v5, v4, 5, v5
ds_write_b128 v5, v[48:51] offset:0
ds_write_b128 v5, v[52:55] offset:16
GEMV_D:
s_mov_b64 exec, s[40:41]
s_waitcnt lgkmcnt(0)
s_barrier
v_lshlrev_b32 v3, 2, v0
ds_read_b32 v20, v3 offset:0
ds_read_b32 v21, v3 offset:2560
ds_read_b32 v22, v3 offset:5120
ds_read_b32 v23, v3 offset:7680
ds_read_b32 v24, v3 offset:10240
ds_read_b32 v25, v3 offset:12800
v_cmp_gt_u32 vcc, 128, v0
s_and_saveexec_b64 s[40:41], vcc
ds_read_b32 v30, v3 offset:2048
ds_read_b32 v31, v3 offset:4608
ds_read_b32 v32, v3 offset:7168
ds_read_b32 v33, v3 offset:9728
ds_read_b32 v34, v3 offset:12288
ds_read_b32 v35, v3 offset:14848
s_mov_b64 exec, s[40:41]
s_waitcnt lgkmcnt(0)
v_add_f32 v20, v20, v21
v_add_f32 v30, v30, v31
v_add_f32 v20, v20, v22
v_add_f32 v30, v30, v32
v_add_f32 v20, v20, v23
v_add_f32 v30, v30, v33
v_add_f32 v20, v20, v24
v_add_f32 v30, v30, v34
v_add_f32 v20, v20, v25
v_add_f32 v30, v30, v35
v_mov_b32 v21, s38
v_mov_b32 v31, s38
s_mul_i32 s27, s2, 5120
s_add_u32 s27, s27, 1048576
v_lshlrev_b32 v3, 3, v0
buffer_store_dwordx2 v[20:21], v3, s[20:23], s27 offen sc1
s_add_u32 s27, s27, 4096
s_and_saveexec_b64 s[40:41], vcc
buffer_store_dwordx2 v[30:31], v3, s[20:23], s27 offen sc1
s_mov_b64 exec, s[40:41]
s_cmp_ge_u32 s2, 40
s_cbranch_scc1 K_END
s_cmp_eq_u32 s24, 0
s_cbranch_scc0 FIN_G_D
v_and_b32 v3, 15, v1
s_lshl_b32 s27, s2, 5
v_lshlrev_b32 v62, 1, v3
buffer_load_ushort v61, v62, s[44:47], s27 offen
s_lshl_b32 s29, s2, 4
v_add_u32 v10, s29, v3
v_and_b32 v11, 7, v10
v_lshlrev_b32 v11, 4, v11
v_lshrrev_b32 v12, 3, v10
v_and_b32 v12, 3, v12
v_lshl_add_u32 v11, v12, 2, v11
v_lshlrev_b32 v10, 3, v10
s_mov_b32 s29, 262144
s_mov_b32 s60, 0
PG:
buffer_load_dword v14, v11, s[56:59], 0 offen offset:128 sc1
buffer_load_dwordx2 v[12:13], v10, s[20:23], s29 offen sc1
s_waitcnt vmcnt(0)
v_cmp_eq_u32 vcc, 0, v14
v_cmp_ne_u32 s[42:43], v14, v13
s_or_b64 vcc, vcc, s[42:43]
s_cbranch_vccz PG_D
s_sleep 1
s_add_u32 s60, s60, 1
s_cmp_lt_u32 s60, 65536
s_cbranch_scc1 PG
PG_D:
v_mov_b32 v60, v12
FIN_G_D:
v_lshrrev_b32 v3, 3, v1
v_lshl_add_u32 v3, v2, 5, v3
v_and_b32 v4, 7, v3
v_lshlrev_b32 v4, 4, v4
v_mul_u32_u24 v3, 5120, v3
v_and_b32 v5, 7, v1
v_lshl_add_u32 v3, v5, 4, v3
s_lshl_b32 s27, s2, 7
s_add_u32 s27, s27, 1048576
s_add_u32 s29, s27, 81920
s_mov_b32 s60, 0
PF:
buffer_load_dwordx4 v[40:43], v4, s[56:59], 0 offen offset:128 sc1
buffer_load_dwordx4 v[20:23], v3, s[20:23], s27 offen offset:0 sc1
s_add_u32 s27, s27, 40960
buffer_load_dwordx4 v[24:27], v3, s[20:23], s27 offen offset:0 sc1
buffer_load_dwordx4 v[28:31], v3, s[20:23], s29 offen offset:0 sc1
s_add_u32 s29, s29, 40960
buffer_load_dwordx4 v[32:35], v3, s[20:23], s29 offen offset:0 sc1
s_sub_u32 s27, s27, 40960
s_sub_u32 s29, s29, 40960
s_waitcnt vmcnt(0)
v_cmp_eq_u32 vcc, 0, v40
v_cmp_ne_u32 s[42:43], v40, v21
s_or_b64 vcc, vcc, s[42:43]
v_cmp_ne_u32 s[42:43], v40, v23
s_or_b64 vcc, vcc, s[42:43]
v_cmp_eq_u32 s[42:43], 0, v41
s_or_b64 vcc, vcc, s[42:43]
v_cmp_ne_u32 s[42:43], v41, v25
s_or_b64 vcc, vcc, s[42:43]
v_cmp_ne_u32 s[42:43], v41, v27
s_or_b64 vcc, vcc, s[42:43]
v_cmp_eq_u32 s[42:43], 0, v42
s_or_b64 vcc, vcc, s[42:43]
v_cmp_ne_u32 s[42:43], v42, v29
s_or_b64 vcc, vcc, s[42:43]
v_cmp_ne_u32 s[42:43], v42, v31
s_or_b64 vcc, vcc, s[42:43]
v_cmp_eq_u32 s[42:43], 0, v43
s_or_b64 vcc, vcc, s[42:43]
v_cmp_ne_u32 s[42:43], v43, v33
s_or_b64 vcc, vcc, s[42:43]
v_cmp_ne_u32 s[42:43], v43, v35
s_or_b64 vcc, vcc, s[42:43]
s_cbranch_vccz PF_D
s_sleep 1
s_add_u32 s60, s60, 1
s_cmp_lt_u32 s60, 65536
s_cbranch_scc1 PF
PF_D:
v_add_f32 v20, v20, v24
v_add_f32 v22, v22, v26
v_add_f32 v20, v20, v28
v_add_f32 v22, v22, v30
v_add_f32 v20, v20, v32
v_add_f32 v22, v22, v34
v_mov_b32 v21, v22
v_lshlrev_b32 v5, 3, v0
ds_write_b64 v5, v[20:21] offset:16384
s_waitcnt lgkmcnt(0)
s_barrier
s_cmp_eq_u32 s24, 0
s_cbranch_scc0 K_END
v_and_b32 v3, 15, v1
v_lshrrev_b32 v4, 4, v1
v_lshlrev_b32 v5, 10, v4
v_lshl_add_u32 v5, v3, 2, v5
ds_read_b32 v32, v5 offset:16384
ds_read_b32 v33, v5 offset:16448
ds_read_b32 v34, v5 offset:16512
ds_read_b32 v35, v5 offset:16576
ds_read_b32 v36, v5 offset:16640
ds_read_b32 v37, v5 offset:16704
ds_read_b32 v38, v5 offset:16768
ds_read_b32 v39, v5 offset:16832
ds_read_b32 v40, v5 offset:16896
ds_read_b32 v41, v5 offset:16960
ds_read_b32 v42, v5 offset:17024
ds_read_b32 v43, v5 offset:17088
ds_read_b32 v44, v5 offset:17152
ds_read_b32 v45, v5 offset:17216
ds_read_b32 v46, v5 offset:17280
ds_read_b32 v47, v5 offset:17344
s_lshl_b32 s27, s2, 5
s_waitcnt lgkmcnt(0)
v_add_f32 v32, v32, v33
v_add_f32 v32, v32, v34
v_add_f32 v32, v32, v35
v_add_f32 v32, v32, v36
v_add_f32 v32, v32, v37
v_add_f32 v32, v32, v38
v_add_f32 v32, v32, v39
v_add_f32 v32, v32, v40
v_add_f32 v32, v32, v41
v_add_f32 v32, v32, v42
v_add_f32 v32, v32, v43
v_add_f32 v32, v32, v44
v_add_f32 v32, v32, v45
v_add_f32 v32, v32, v46
v_add_f32 v32, v32, v47
v_lshlrev_b32 v5, 2, v1
ds_write_b32 v5, v32 offset:24576
v_lshlrev_b32 v6, 2, v3
s_waitcnt lgkmcnt(0)
ds_read_b32 v40, v6 offset:24576
ds_read_b32 v41, v6 offset:24640
ds_read_b32 v42, v6 offset:24704
ds_read_b32 v43, v6 offset:24768
s_waitcnt lgkmcnt(0)
v_add_f32 v40, v40, v41
v_add_f32 v42, v42, v43
v_add_f32 v40, v40, v42
v_cvt_pk_bf16_f32 v10, v40, v40
v_lshlrev_b32 v40, 16, v10
v_mul_f32 v40, v40, v60
v_cvt_pk_bf16_f32 v10, v40, v40
v_lshlrev_b32 v40, 16, v10
v_lshlrev_b32 v9, 16, v61
v_add_f32 v40, v40, v9
v_cvt_pk_bf16_f32 v40, v40, v40
s_mov_b32 s92, s76
s_and_b32 s93, s77, 0xffff
s_mov_b32 s94, 0x500
s_mov_b32 s95, 0x00020000
v_cmp_gt_u32 vcc, 16, v1
s_and_saveexec_b64 s[40:41], vcc
buffer_store_short v40, v62, s[92:95], s27 offen
K_END:
s_endpgm
.section .rodata,"a"
.p2align 6
.amdhsa_kernel recurrent_scan__sliding_block_cached__mixer_token_mlp__decode_kernel
  .amdhsa_next_free_vgpr 256
  .amdhsa_next_free_sgpr 102
  .amdhsa_accum_offset 256
  .amdhsa_group_segment_fixed_size 0
  .amdhsa_kernarg_size 104
  .amdhsa_user_sgpr_count 2
  .amdhsa_user_sgpr_kernarg_segment_ptr 1
  .amdhsa_system_sgpr_workgroup_id_x 1
.end_amdhsa_kernel
```
